```python
import torch

def _softmax(x, axis=-1):
    return torch.softmax(x, dim=axis)
def _gelu(x):
    return torch.nn.functional.gelu(x, approximate="tanh")
def _silu(x):
    return torch.nn.functional.silu(x)
def _sigmoid(x):
    return torch.sigmoid(x)
def _layernorm(x, axis=-1, eps=1e-5):
    m = x.mean(dim=axis, keepdim=True)
    v = x.var(dim=axis, keepdim=True, unbiased=False)
    return (x - m) / torch.sqrt(v + eps)
def _scatter_add(tgt, idx, src, axis=0):
    return tgt.clone().index_add_(axis, idx, src)
def _segment_sum(src, seg, n):
    out = torch.zeros((n,) + src.shape[1:], dtype=src.dtype)
    return out.index_add_(0, seg, src)
def _pad(x, pw):
    flat = tuple(v for pair in reversed(pw) for v in pair)
    return torch.nn.functional.pad(x, flat)

kernel_name = 'standalone__mixer_s_mlp__prompt'

def setup_inputs():

    _w = (lambda a: (lambda t: t.to(torch.bfloat16) if t.is_floating_point() else t)(torch.as_tensor(a)))
    B, S, D, F = 1, 2048, 448, 1792
    return {
        "x":  _w((lambda *s: torch.randn(*s, dtype=torch.bfloat16) * 0.4)(B, S, D)),
        "w1": _w((lambda *s: torch.randn(*s, dtype=torch.bfloat16) * 3.2)(D, D) * (D ** -0.5)),
        "w2": _w((lambda *s: torch.randn(*s, dtype=torch.bfloat16) * 3.2)(D, D) * (D ** -0.5)),
        "w3": _w((lambda *s: torch.randn(*s, dtype=torch.bfloat16) * 3.2)(D, F) * (D ** -0.5)),
        "w4": _w((lambda *s: torch.randn(*s, dtype=torch.bfloat16) * 0.8)(F, D) * (F ** -0.5)),
    }

def reference(x, w1, w2, w3, w4):
    B, S, D = x.shape
    h = _gelu(_layernorm(x, axis=-1) @ w1)
    c = D // 4
    g0 = _pad(h[:, :, 0*c:1*c], ((0, 0), (1, 0), (0, 0)))[:, :S, :]
    g1 = _pad(h[:, :, 1*c:2*c], ((0, 0), (0, 1), (0, 0)))[:, 1:, :]
    g2 = _pad(h[:, :, 2*c:3*c], ((0, 0), (2, 0), (0, 0)))[:, :S, :]
    g3 = _pad(h[:, :, 3*c:   ], ((0, 0), (0, 2), (0, 0)))[:, 2:, :]
    hs = torch.concatenate([g0, g1, g2, g3], axis=-1) @ w2
    x1 = x + hs
    h2 = _gelu(_layernorm(x1, axis=-1) @ w3) @ w4
    return x1 + h2
```

```asm
; @launch grid=(256,1,1) block=(512,1,1) lds=163840
.amdgcn_target "amdgcn-amd-amdhsa--gfx950"
.text
.globl standalone__mixer_s_mlp__prompt_kernel
.p2align 8
.type standalone__mixer_s_mlp__prompt_kernel,@function
standalone__mixer_s_mlp__prompt_kernel:
    s_cmp_ge_u32 s2, 256
    s_cbranch_scc1 Lend
    s_load_dwordx16 s[4:19], s[0:1], 0
    s_lshr_b32 s49, s2, 3
    s_getpc_b64 s[20:21]
Lpc:
    s_lshl_b32 s22, s49, 10
    v_min_u32 v2, 7, v0
    v_lshl_add_u32 v2, v2, 7, s22
    v_min_u32 v2, Lhot_end-Lpc-4, v2
    global_load_dword v255, v2, s[20:21]
    v_lshrrev_b32 v1, 6, v0
    v_lshlrev_b32 v10, 4, v0
    v_and_b32 v0, 63, v0
    v_readfirstlane_b32 s58, v1
    s_mul_i32 s56, s49, 37
    s_lshr_b32 s56, s56, 8
    s_mul_i32 s50, s56, 7
    s_sub_u32 s49, s49, s50
    s_and_b32 s50, s2, 7
    s_lshl_b32 s50, s50, 2
    s_cmp_eq_u32 s56, 4
    s_cbranch_scc0 Lworker
    s_and_b32 s3, s2, 31
    s_mul_i32 s3, s3, 12544
    v_lshlrev_b32 v2, 1, v10
    v_min_u32 v2, 12540, v2
    s_waitcnt lgkmcnt(0)
    s_mov_b64 s[24:25], s[6:7]
    s_mov_b32 s26, 401408
    s_mov_b32 s27, 0x20000
    s_mov_b64 s[28:29], s[8:9]
    s_mov_b32 s30, 401408
    s_mov_b32 s31, 0x20000
    buffer_load_dword v24, v2, s[24:27], s3 offen
    buffer_load_dword v24, v2, s[28:31], s3 offen
    s_branch Lhelper
Lworker:
    s_add_u32 s50, s50, s56
    v_lshrrev_b32 v6, 3, v0
    v_and_b32 v7, 7, v0
    v_and_b32 v20, 6, v6
    v_xor_b32 v20, v20, v7
    v_lshlrev_b32 v20, 4, v20
    v_mul_u32_u24 v21, 896, v6
    v_add_u32 v11, v20, v21
    s_add_u32 s67, s58, s49
    s_and_b32 s67, s67, 7
    s_lshl3_add_u32 s48, s50, s67
    s_mul_i32 s48, s48, 7168
    s_sub_u32 s48, s48, 1792
    v_add_u32 v12, s48, v11
    s_lshl_b32 s60, s49, 7
    s_lshl_b32 s67, s67, 10
    s_mov_b32 m0, s67
    s_and_b32 s48, s58, 3
    s_add_u32 s61, s60, 128
    s_cmpk_eq_u32 s61, 896
    s_cselect_b32 s61, 0, s61
    s_add_u32 s62, s61, 128
    s_cmpk_eq_u32 s62, 896
    s_cselect_b32 s62, 0, s62
    s_add_u32 s63, s62, 128
    s_cmpk_eq_u32 s63, 896
    s_cselect_b32 s63, 0, s63
    s_add_u32 s64, s63, 128
    s_cmpk_eq_u32 s64, 896
    s_cselect_b32 s64, 0, s64
    s_add_u32 s65, s64, 128
    s_cmpk_eq_u32 s65, 896
    s_cselect_b32 s65, 0, s65
    s_add_u32 s66, s65, 128
    s_cmpk_eq_u32 s66, 896
    s_cselect_b32 s66, 0, s66
    s_waitcnt lgkmcnt(0)
    s_mov_b64 s[20:21], s[4:5]
    s_mov_b32 s22, 1835008
    s_mov_b32 s23, 0x20000
    buffer_load_dwordx4 v12, s[20:23], s60 offen lds
    s_cmp_ge_u32 s58, 4
    s_cbranch_scc1 LB
    s_setprio 3
    s_lshl_b32 s58, s48, 10
    s_add_u32 m0, s67, 8704
    s_nop 0
    buffer_load_dwordx4 v12, s[20:23], s61 offen lds
    s_add_u32 m0, s67, 17408
    s_nop 0
    buffer_load_dwordx4 v12, s[20:23], s62 offen lds
    s_add_u32 m0, s67, 26112
    s_nop 0
    buffer_load_dwordx4 v12, s[20:23], s63 offen lds
    s_add_u32 m0, s67, 34816
    s_nop 0
    buffer_load_dwordx4 v12, s[20:23], s64 offen lds
    s_add_u32 m0, s67, 43520
    s_nop 0
    buffer_load_dwordx4 v12, s[20:23], s65 offen lds
    s_add_u32 m0, s67, 52224
    s_nop 0
    buffer_load_dwordx4 v12, s[20:23], s66 offen lds
    s_xor_b32 s51, s50, 1
    s_and_b32 s52, s50, 1
    s_lshl_b32 s54, s50, 19
    s_lshl_b32 s55, s51, 19
    s_mov_b32 s59, 0
    v_lshlrev_b32 v1, 4, v0
    v_mov_b32 v2, 0
    s_mov_b64 s[44:45], s[18:19]
    s_mov_b32 s46, 16777216
    s_mov_b32 s47, 0x20000
    s_mov_b64 s[40:41], s[14:15]
    s_mov_b32 s42, 1835008
    s_mov_b32 s43, 0x20000
    s_mov_b64 s[32:33], s[10:11]
    s_mov_b32 s34, 1605632
    s_mov_b32 s35, 0x20000
    s_and_b32 s4, s54, s55
    s_add_u32 s4, s4, 384
    s_load_dword s53, s[44:45], s4
    s_cmp_eq_u32 s48, 3
    s_cbranch_scc0 Lnox2
    s_lshl_b32 s3, s50, 6
    s_add_u32 s3, s3, 62
    s_mul_i32 s3, s3, 896
    v_add_u32 v13, s3, v11
    s_mov_b32 s67, 8192
    s_mov_b32 exec_hi, 0
    s_mov_b32 m0, 8192
    s_nop 0
    buffer_load_dwordx4 v13, s[20:23], s60 offen lds
    s_mov_b32 m0, 16896
    s_nop 0
    buffer_load_dwordx4 v13, s[20:23], s61 offen lds
    s_mov_b32 m0, 25600
    s_nop 0
    buffer_load_dwordx4 v13, s[20:23], s62 offen lds
    s_mov_b32 m0, 34304
    s_nop 0
    buffer_load_dwordx4 v13, s[20:23], s63 offen lds
    s_mov_b32 m0, 43008
    s_nop 0
    buffer_load_dwordx4 v13, s[20:23], s64 offen lds
    s_mov_b32 m0, 51712
    s_nop 0
    buffer_load_dwordx4 v13, s[20:23], s65 offen lds
    s_mov_b32 m0, 60416
    s_nop 0
    buffer_load_dwordx4 v13, s[20:23], s66 offen lds
    s_mov_b64 exec, -1
Lnox2:
    v_and_b32 v4, 15, v0
    v_lshrrev_b32 v5, 4, v0
    v_mov_b32 v9, 163328
    v_min_u32 v8, 1, v0
    v_lshlrev_b32 v8, 31, v8
    v_mov_b32 v24, 0
    v_mov_b32 v25, 0
    v_mov_b32 v26, 0
    v_mov_b32 v27, 0
    v_lshl_add_u32 v20, v0, 3, v9
    ds_write_b64 v20, v[24:25]
    ds_write_b128 v1, v[24:27] offset:60928
    v_add_u32 v60, s67, v1
    v_mov_b32 v62, 0x3f803f80
    s_cmp_eq_u32 s48, 3
    s_cselect_b32 s4, 39, 7
    v_and_b32 v20, s4, v0
    v_min_u32 v20, 1, v20
    v_lshlrev_b32 v20, 31, v20
    v_or_b32 v61, v20, v0
    v_mov_b32 v25, 0x80000000
    s_lshl_b32 s3, s49, 2
    s_add_u32 s3, s3, s48
    s_mov_b32 s4, 1
    s_cmp_ge_u32 s3, 7
    s_cselect_b32 s4, 3, s4
    s_cmp_ge_u32 s3, 14
    s_cselect_b32 s4, 0, s4
    s_cmp_ge_u32 s3, 21
    s_cselect_b32 s4, 4, s4
    v_add_u32 v20, s4, v4
    v_and_b32 v21, 6, v20
    v_xor_b32 v21, v21, v5
    v_lshlrev_b32 v21, 4, v21
    v_lshl_add_u32 v14, v20, 7, v21
    v_xor_b32 v15, 64, v14
    v_lshlrev_b32 v17, 3, v20
    v_lshrrev_b32 v21, 3, v20
    v_lshl_add_u32 v19, v21, 6, v17
    v_lshrrev_b32 v20, 2, v4
    v_and_b32 v21, 3, v4
    v_lshrrev_b32 v22, 1, v20
    v_and_b32 v23, 1, v5
    v_lshl_or_b32 v22, v23, 1, v22
    v_xor_b32 v22, s48, v22
    v_lshlrev_b32 v22, 5, v22
    v_lshl_add_u32 v22, v21, 3, v22
    v_lshl_add_u32 v23, v5, 3, v20
    v_lshl_add_u32 v22, v23, 7, v22
    v_add_u32 v16, 62464, v22
    v_xor_b32 v22, s48, v20
    v_lshlrev_b32 v22, 6, v22
    v_lshl_add_u32 v22, v21, 3, v22
    v_and_b32 v23, 1, v5
    v_lshl_add_u32 v22, v23, 5, v22
    v_lshrrev_b32 v23, 1, v5
    v_lshl_add_u32 v23, v23, 2, v20
    v_lshl_add_u32 v12, v23, 8, v22
    v_add_u32 v13, 73728, v12
    v_lshrrev_b32 v20, 5, v0
    v_mul_u32_u24 v20, 14336, v20
    v_and_b32 v21, 31, v0
    v_lshl_add_u32 v18, v21, 4, v20
    v_mov_b32 v88, 0x3f803f80
    v_mov_b32 v89, 0x3f803f80
    v_mov_b32 v90, 0x3f803f80
    v_mov_b32 v91, 0x3f803f80
    s_mul_i32 s8, s50, 112
    s_add_u32 s8, s8, s3
    s_lshl_b32 s8, s8, 9
    s_add_u32 s10, s8, 28672
    s_lshl_b32 s9, s3, 2
    s_add_u32 s9, s9, s54
    s_mul_i32 s5, s52, 7
    s_add_u32 s5, s5, s49
    s_lshl_b32 s5, s5, 2
    s_and_b32 s7, s54, s55
    s_add_u32 s5, s5, s7
    s_min_u32 s6, s48, 1
    s_lshl_b32 s6, s6, 31
    v_or_b32 v21, s6, v8
    s_getreg_b32 s6, hwreg(HW_REG_XCC_ID, 0, 4)
    s_waitcnt lgkmcnt(0)
    s_add_u32 s53, s53, 0x9e3779b9
    s_and_b32 s53, s53, 0xffffffe0
    s_or_b32 s53, s53, 16
    v_mov_b32 v3, s53
    s_waitcnt vmcnt(0)
    s_lshl3_add_u32 s4, s48, s49
    s_lshl_b32 s4, 1, s4
    s_and_b32 s4, s4, 536887423
    s_cbranch_scc0 Lnostats
    ds_read_b128 v[32:35], v60 offset:0
    ds_read_b128 v[36:39], v60 offset:8704
    ds_read_b128 v[40:43], v60 offset:17408
    ds_read_b128 v[44:47], v60 offset:26112
    ds_read_b128 v[48:51], v60 offset:34816
    ds_read_b128 v[52:55], v60 offset:43520
    ds_read_b128 v[56:59], v60 offset:52224
    v_or_b32 v20, s6, v3
    buffer_store_dword v20, v21, s[44:47], s5 offen offset:256
    s_waitcnt lgkmcnt(6)
    v_dot2_f32_bf16 v28, v32, v62, 0
    v_dot2_f32_bf16 v29, v32, v32, 0
    v_dot2_f32_bf16 v30, v33, v62, 0
    v_dot2_f32_bf16 v31, v33, v33, 0
    v_dot2_f32_bf16 v28, v34, v62, v28
    v_dot2_f32_bf16 v29, v34, v34, v29
    v_dot2_f32_bf16 v30, v35, v62, v30
    v_dot2_f32_bf16 v31, v35, v35, v31
    s_waitcnt lgkmcnt(5)
    v_dot2_f32_bf16 v28, v36, v62, v28
    v_dot2_f32_bf16 v29, v36, v36, v29
    v_dot2_f32_bf16 v30, v37, v62, v30
    v_dot2_f32_bf16 v31, v37, v37, v31
    v_dot2_f32_bf16 v28, v38, v62, v28
    v_dot2_f32_bf16 v29, v38, v38, v29
    v_dot2_f32_bf16 v30, v39, v62, v30
    v_dot2_f32_bf16 v31, v39, v39, v31
    s_waitcnt lgkmcnt(4)
    v_dot2_f32_bf16 v28, v40, v62, v28
    v_dot2_f32_bf16 v29, v40, v40, v29
    v_dot2_f32_bf16 v30, v41, v62, v30
    v_dot2_f32_bf16 v31, v41, v41, v31
    v_dot2_f32_bf16 v28, v42, v62, v28
    v_dot2_f32_bf16 v29, v42, v42, v29
    v_dot2_f32_bf16 v30, v43, v62, v30
    v_dot2_f32_bf16 v31, v43, v43, v31
    s_waitcnt lgkmcnt(3)
    v_dot2_f32_bf16 v28, v44, v62, v28
    v_dot2_f32_bf16 v29, v44, v44, v29
    v_dot2_f32_bf16 v30, v45, v62, v30
    v_dot2_f32_bf16 v31, v45, v45, v31
    v_dot2_f32_bf16 v28, v46, v62, v28
    v_dot2_f32_bf16 v29, v46, v46, v29
    v_dot2_f32_bf16 v30, v47, v62, v30
    v_dot2_f32_bf16 v31, v47, v47, v31
    s_waitcnt lgkmcnt(2)
    v_dot2_f32_bf16 v28, v48, v62, v28
    v_dot2_f32_bf16 v29, v48, v48, v29
    v_dot2_f32_bf16 v30, v49, v62, v30
    v_dot2_f32_bf16 v31, v49, v49, v31
    v_dot2_f32_bf16 v28, v50, v62, v28
    v_dot2_f32_bf16 v29, v50, v50, v29
    v_dot2_f32_bf16 v30, v51, v62, v30
    v_dot2_f32_bf16 v31, v51, v51, v31
    s_waitcnt lgkmcnt(1)
    v_dot2_f32_bf16 v28, v52, v62, v28
    v_dot2_f32_bf16 v29, v52, v52, v29
    v_dot2_f32_bf16 v30, v53, v62, v30
    v_dot2_f32_bf16 v31, v53, v53, v31
    v_dot2_f32_bf16 v28, v54, v62, v28
    v_dot2_f32_bf16 v29, v54, v54, v29
    v_dot2_f32_bf16 v30, v55, v62, v30
    v_dot2_f32_bf16 v31, v55, v55, v31
    s_waitcnt lgkmcnt(0)
    v_dot2_f32_bf16 v28, v56, v62, v28
    v_dot2_f32_bf16 v29, v56, v56, v29
    v_dot2_f32_bf16 v30, v57, v62, v30
    v_dot2_f32_bf16 v31, v57, v57, v31
    v_dot2_f32_bf16 v28, v58, v62, v28
    v_dot2_f32_bf16 v29, v58, v58, v29
    v_dot2_f32_bf16 v30, v59, v62, v30
    v_dot2_f32_bf16 v31, v59, v59, v31
    s_nop 1
    v_add_f32 v28, v28, v30
    v_add_f32 v29, v29, v31
    s_nop 0
    v_add_f32_dpp v28, v28, v28 quad_perm:[1,0,3,2] row_mask:0xf bank_mask:0xf
    v_add_f32_dpp v29, v29, v29 quad_perm:[1,0,3,2] row_mask:0xf bank_mask:0xf
    s_nop 0
    v_add_f32_dpp v28, v28, v28 quad_perm:[2,3,0,1] row_mask:0xf bank_mask:0xf
    v_add_f32_dpp v29, v29, v29 quad_perm:[2,3,0,1] row_mask:0xf bank_mask:0xf
    s_nop 0
    v_add_f32_dpp v28, v28, v28 row_half_mirror row_mask:0xf bank_mask:0xf
    v_add_f32_dpp v29, v29, v29 row_half_mirror row_mask:0xf bank_mask:0xf
    v_mul_f32 v28, 0xbb124925, v28
    v_mul_f32 v29, 0x3b124925, v29
    v_fma_f32 v29, -v28, v28, v29
    v_max_f32 v29, 0, v29
    v_cvt_pk_bf16_f32 v29, v29, v29
    v_and_b32 v29, 0xffff0000, v29
    v_add_f32 v29, 0x3727c5ac, v29
    v_cvt_pk_bf16_f32 v29, v29, v29
    v_and_b32 v29, 0xffff0000, v29
    v_sqrt_f32 v29, v29
    s_lshr_b32 s4, s67, 3
    v_add_u32 v25, s4, v61
    v_cvt_pk_bf16_f32 v28, v28, v29
    v_mov_b32 v29, v3
    buffer_store_dwordx2 v[28:29], v25, s[44:47], s54 offen offset:2048
Lnostats:
    s_or_b32 s6, s6, s53
    v_min_u32 v169, 13, v0
    v_lshlrev_b32 v169, 2, v169
    v_add_u32 v170, 163584, v169
    v_mov_b32 v20, 0xc0135761
    v_mov_b32 v21, 0xbdd2d3e8
    v_mov_b32 v22, 1.0
    s_setprio 0
    s_barrier
    ds_read_b64_tr_b16 v[32:33], v16 offset:0
    ds_read_b64_tr_b16 v[34:35], v16 offset:512
    ds_read_b128 v[112:115], v14 offset:0
    ds_read_b128 v[116:119], v14 offset:2048
    ds_read_b64_tr_b16 v[36:37], v16 offset:4096
    ds_read_b64_tr_b16 v[38:39], v16 offset:4608
    ds_read_b128 v[120:123], v14 offset:4096
    ds_read_b128 v[124:127], v14 offset:6144
    ds_read_b128 v[128:131], v15 offset:0
    ds_read_b128 v[132:135], v15 offset:2048
    s_waitcnt lgkmcnt(8)
    v_mfma_f32_16x16x32_bf16 v[92:95], v[32:35], v[88:91], 0
    ds_read_b64_tr_b16 v[40:41], v16 offset:8192
    ds_read_b64_tr_b16 v[42:43], v16 offset:8704
    s_waitcnt lgkmcnt(8)
    v_mfma_f32_16x16x32_bf16 v[100:103], v[32:35], v[116:119], 0
    ds_read_b128 v[136:139], v15 offset:4096
    v_mfma_f32_16x16x32_bf16 v[96:99], v[32:35], v[112:115], 0
    ds_read_b128 v[140:143], v15 offset:6144
    s_waitcnt lgkmcnt(6)
    v_mfma_f32_16x16x32_bf16 v[108:111], v[32:35], v[124:127], 0
    ds_read_b128 v[112:115], v14 offset:8704
    v_mfma_f32_16x16x32_bf16 v[104:107], v[32:35], v[120:123], 0
    ds_read_b128 v[116:119], v14 offset:10752
    v_mfma_f32_16x16x32_bf16 v[92:95], v[36:39], v[88:91], v[92:95]
    s_barrier
    ds_read_b64_tr_b16 v[44:45], v16 offset:12288
    ds_read_b64_tr_b16 v[46:47], v16 offset:12800
    s_waitcnt lgkmcnt(8)
    v_mfma_f32_16x16x32_bf16 v[100:103], v[36:39], v[132:135], v[100:103]
    ds_read_b128 v[120:123], v14 offset:12800
    v_mfma_f32_16x16x32_bf16 v[96:99], v[36:39], v[128:131], v[96:99]
    ds_read_b128 v[124:127], v14 offset:14848
    s_waitcnt lgkmcnt(6)
    v_mfma_f32_16x16x32_bf16 v[108:111], v[36:39], v[140:143], v[108:111]
    ds_read_b128 v[128:131], v15 offset:8704
    v_mfma_f32_16x16x32_bf16 v[104:107], v[36:39], v[136:139], v[104:107]
    ds_read_b128 v[132:135], v15 offset:10752
    v_mfma_f32_16x16x32_bf16 v[92:95], v[40:43], v[88:91], v[92:95]
    ds_read_b64_tr_b16 v[48:49], v16 offset:16384
    ds_read_b64_tr_b16 v[50:51], v16 offset:16896
    s_waitcnt lgkmcnt(8)
    v_mfma_f32_16x16x32_bf16 v[100:103], v[40:43], v[116:119], v[100:103]
    ds_read_b128 v[136:139], v15 offset:12800
    v_mfma_f32_16x16x32_bf16 v[96:99], v[40:43], v[112:115], v[96:99]
    ds_read_b128 v[140:143], v15 offset:14848
    s_waitcnt lgkmcnt(6)
    v_mfma_f32_16x16x32_bf16 v[108:111], v[40:43], v[124:127], v[108:111]
    ds_read_b128 v[112:115], v14 offset:17408
    v_mfma_f32_16x16x32_bf16 v[104:107], v[40:43], v[120:123], v[104:107]
    ds_read_b128 v[116:119], v14 offset:19456
    v_mfma_f32_16x16x32_bf16 v[92:95], v[44:47], v[88:91], v[92:95]
    ds_read_b64_tr_b16 v[52:53], v16 offset:20480
    ds_read_b64_tr_b16 v[54:55], v16 offset:20992
    s_waitcnt lgkmcnt(8)
    v_mfma_f32_16x16x32_bf16 v[100:103], v[44:47], v[132:135], v[100:103]
    ds_read_b128 v[120:123], v14 offset:21504
    v_mfma_f32_16x16x32_bf16 v[96:99], v[44:47], v[128:131], v[96:99]
    ds_read_b128 v[124:127], v14 offset:23552
    s_waitcnt lgkmcnt(6)
    v_mfma_f32_16x16x32_bf16 v[108:111], v[44:47], v[140:143], v[108:111]
    ds_read_b128 v[128:131], v15 offset:17408
    v_mfma_f32_16x16x32_bf16 v[104:107], v[44:47], v[136:139], v[104:107]
    ds_read_b128 v[132:135], v15 offset:19456
    v_mfma_f32_16x16x32_bf16 v[92:95], v[48:51], v[88:91], v[92:95]
    ds_read_b64_tr_b16 v[56:57], v16 offset:24576
    ds_read_b64_tr_b16 v[58:59], v16 offset:25088
    s_waitcnt lgkmcnt(8)
    v_mfma_f32_16x16x32_bf16 v[100:103], v[48:51], v[116:119], v[100:103]
    ds_read_b128 v[136:139], v15 offset:21504
    v_mfma_f32_16x16x32_bf16 v[96:99], v[48:51], v[112:115], v[96:99]
    ds_read_b128 v[140:143], v15 offset:23552
    s_waitcnt lgkmcnt(6)
    v_mfma_f32_16x16x32_bf16 v[108:111], v[48:51], v[124:127], v[108:111]
    ds_read_b128 v[112:115], v14 offset:26112
    v_mfma_f32_16x16x32_bf16 v[104:107], v[48:51], v[120:123], v[104:107]
    ds_read_b128 v[116:119], v14 offset:28160
    v_mfma_f32_16x16x32_bf16 v[92:95], v[52:55], v[88:91], v[92:95]
    s_barrier
    ds_read_b64_tr_b16 v[60:61], v16 offset:28672
    ds_read_b64_tr_b16 v[62:63], v16 offset:29184
    s_waitcnt lgkmcnt(8)
    v_mfma_f32_16x16x32_bf16 v[100:103], v[52:55], v[132:135], v[100:103]
    ds_read_b128 v[120:123], v14 offset:30208
    v_mfma_f32_16x16x32_bf16 v[96:99], v[52:55], v[128:131], v[96:99]
    ds_read_b128 v[124:127], v14 offset:32256
    s_waitcnt lgkmcnt(6)
    v_mfma_f32_16x16x32_bf16 v[108:111], v[52:55], v[140:143], v[108:111]
    ds_read_b128 v[128:131], v15 offset:26112
    v_mfma_f32_16x16x32_bf16 v[104:107], v[52:55], v[136:139], v[104:107]
    ds_read_b128 v[132:135], v15 offset:28160
    v_mfma_f32_16x16x32_bf16 v[92:95], v[56:59], v[88:91], v[92:95]
    ds_read_b64_tr_b16 v[64:65], v16 offset:32768
    ds_read_b64_tr_b16 v[66:67], v16 offset:33280
    s_waitcnt lgkmcnt(8)
    v_mfma_f32_16x16x32_bf16 v[100:103], v[56:59], v[116:119], v[100:103]
    ds_read_b128 v[136:139], v15 offset:30208
    v_mfma_f32_16x16x32_bf16 v[96:99], v[56:59], v[112:115], v[96:99]
    ds_read_b128 v[140:143], v15 offset:32256
    s_waitcnt lgkmcnt(6)
    v_mfma_f32_16x16x32_bf16 v[108:111], v[56:59], v[124:127], v[108:111]
    ds_read_b128 v[112:115], v14 offset:34816
    v_mfma_f32_16x16x32_bf16 v[104:107], v[56:59], v[120:123], v[104:107]
    ds_read_b128 v[116:119], v14 offset:36864
    v_mfma_f32_16x16x32_bf16 v[92:95], v[60:63], v[88:91], v[92:95]
    ds_read_b64_tr_b16 v[68:69], v16 offset:36864
    ds_read_b64_tr_b16 v[70:71], v16 offset:37376
    s_waitcnt lgkmcnt(8)
    v_mfma_f32_16x16x32_bf16 v[100:103], v[60:63], v[132:135], v[100:103]
    ds_read_b128 v[120:123], v14 offset:38912
    v_mfma_f32_16x16x32_bf16 v[96:99], v[60:63], v[128:131], v[96:99]
    ds_read_b128 v[124:127], v14 offset:40960
    s_waitcnt lgkmcnt(6)
    v_mfma_f32_16x16x32_bf16 v[108:111], v[60:63], v[140:143], v[108:111]
    ds_read_b128 v[128:131], v15 offset:34816
    v_mfma_f32_16x16x32_bf16 v[104:107], v[60:63], v[136:139], v[104:107]
    ds_read_b128 v[132:135], v15 offset:36864
    v_mfma_f32_16x16x32_bf16 v[92:95], v[64:67], v[88:91], v[92:95]
    ds_read_b64_tr_b16 v[72:73], v16 offset:40960
    ds_read_b64_tr_b16 v[74:75], v16 offset:41472
    s_waitcnt lgkmcnt(8)
    v_mfma_f32_16x16x32_bf16 v[100:103], v[64:67], v[116:119], v[100:103]
    ds_read_b128 v[136:139], v15 offset:38912
    v_mfma_f32_16x16x32_bf16 v[96:99], v[64:67], v[112:115], v[96:99]
    ds_read_b128 v[140:143], v15 offset:40960
    s_waitcnt lgkmcnt(6)
    v_mfma_f32_16x16x32_bf16 v[108:111], v[64:67], v[124:127], v[108:111]
    ds_read_b128 v[112:115], v14 offset:43520
    v_mfma_f32_16x16x32_bf16 v[104:107], v[64:67], v[120:123], v[104:107]
    ds_read_b128 v[116:119], v14 offset:45568
    v_mfma_f32_16x16x32_bf16 v[92:95], v[68:71], v[88:91], v[92:95]
    s_barrier
    ds_read_b64_tr_b16 v[76:77], v16 offset:45056
    ds_read_b64_tr_b16 v[78:79], v16 offset:45568
    s_waitcnt lgkmcnt(8)
    v_mfma_f32_16x16x32_bf16 v[100:103], v[68:71], v[132:135], v[100:103]
    ds_read_b128 v[120:123], v14 offset:47616
    v_mfma_f32_16x16x32_bf16 v[96:99], v[68:71], v[128:131], v[96:99]
    ds_read_b128 v[124:127], v14 offset:49664
    s_waitcnt lgkmcnt(6)
    v_mfma_f32_16x16x32_bf16 v[108:111], v[68:71], v[140:143], v[108:111]
    ds_read_b128 v[128:131], v15 offset:43520
    v_mfma_f32_16x16x32_bf16 v[104:107], v[68:71], v[136:139], v[104:107]
    ds_read_b128 v[132:135], v15 offset:45568
    v_mfma_f32_16x16x32_bf16 v[92:95], v[72:75], v[88:91], v[92:95]
    ds_read_b64_tr_b16 v[80:81], v16 offset:49152
    ds_read_b64_tr_b16 v[82:83], v16 offset:49664
    s_waitcnt lgkmcnt(8)
    v_mfma_f32_16x16x32_bf16 v[100:103], v[72:75], v[116:119], v[100:103]
    ds_read_b128 v[136:139], v15 offset:47616
    v_mfma_f32_16x16x32_bf16 v[96:99], v[72:75], v[112:115], v[96:99]
    ds_read_b128 v[140:143], v15 offset:49664
    s_waitcnt lgkmcnt(6)
    v_mfma_f32_16x16x32_bf16 v[108:111], v[72:75], v[124:127], v[108:111]
    ds_read_b128 v[112:115], v14 offset:52224
    v_mfma_f32_16x16x32_bf16 v[104:107], v[72:75], v[120:123], v[104:107]
    ds_read_b128 v[116:119], v14 offset:54272
    v_mfma_f32_16x16x32_bf16 v[92:95], v[76:79], v[88:91], v[92:95]
    ds_read_b64_tr_b16 v[84:85], v16 offset:53248
    ds_read_b64_tr_b16 v[86:87], v16 offset:53760
    s_waitcnt lgkmcnt(8)
    v_mfma_f32_16x16x32_bf16 v[100:103], v[76:79], v[132:135], v[100:103]
    ds_read_b128 v[120:123], v14 offset:56320
    v_mfma_f32_16x16x32_bf16 v[96:99], v[76:79], v[128:131], v[96:99]
    ds_read_b128 v[124:127], v14 offset:58368
    s_waitcnt lgkmcnt(6)
    v_mfma_f32_16x16x32_bf16 v[108:111], v[76:79], v[140:143], v[108:111]
    ds_read_b128 v[128:131], v15 offset:52224
    v_mfma_f32_16x16x32_bf16 v[104:107], v[76:79], v[136:139], v[104:107]
    ds_read_b128 v[132:135], v15 offset:54272
    s_waitcnt lgkmcnt(6)
    v_mfma_f32_16x16x32_bf16 v[100:103], v[80:83], v[116:119], v[100:103]
    ds_read_b128 v[136:139], v15 offset:56320
    v_mfma_f32_16x16x32_bf16 v[96:99], v[80:83], v[112:115], v[96:99]
    ds_read_b128 v[140:143], v15 offset:58368
    s_waitcnt lgkmcnt(0)
    s_barrier
    v_mfma_f32_16x16x32_bf16 v[108:111], v[80:83], v[124:127], v[108:111]
    v_mfma_f32_16x16x32_bf16 v[104:107], v[80:83], v[120:123], v[104:107]
    ds_read_b64 v[144:145], v17 offset:60928
    ds_read_b64 v[146:147], v17 offset:61056
    ds_read_b64 v[148:149], v17 offset:61184
    ds_read_b64 v[150:151], v17 offset:61312
    ds_read_b32 v168, v170
    v_mfma_f32_16x16x32_bf16 v[92:95], v[80:83], v[88:91], v[92:95]
    v_mfma_f32_16x16x32_bf16 v[92:95], v[84:87], v[88:91], v[92:95]
    v_mfma_f32_16x16x32_bf16 v[100:103], v[84:87], v[132:135], v[100:103]
    v_mfma_f32_16x16x32_bf16 v[96:99], v[84:87], v[128:131], v[96:99]
    v_mfma_f32_16x16x32_bf16 v[108:111], v[84:87], v[140:143], v[108:111]
    v_mfma_f32_16x16x32_bf16 v[104:107], v[84:87], v[136:139], v[104:107]
    s_waitcnt lgkmcnt(0)
    v_bitop3_b32 v23, v145, v147, v3 bitop3:0x7e
    v_bitop3_b32 v24, v149, v151, v3 bitop3:0x7e
    v_or_b32 v23, v23, v24
    v_cmp_ne_u32 vcc, 0, v23
    s_cbranch_vccnz Lstslow
Lstback:
    v_and_b32 v145, 0xffff0000, v144
    v_and_b32 v147, 0xffff0000, v146
    v_and_b32 v149, 0xffff0000, v148
    v_and_b32 v151, 0xffff0000, v150
    v_rcp_f32 v145, v145
    v_rcp_f32 v147, v147
    v_rcp_f32 v149, v149
    v_rcp_f32 v151, v151
    v_lshlrev_b32 v144, 16, v144
    v_lshlrev_b32 v146, 16, v146
    v_lshlrev_b32 v148, 16, v148
    v_lshlrev_b32 v150, 16, v150
    v_cmp_ne_u32 vcc, s6, v168
    s_cbranch_vccnz LA_retry
LA_fast:
    s_nop 1
    .p2align 3
    v_pk_fma_f32 v[96:97], v[92:93], v[144:145], v[96:97] op_sel_hi:[1,0,1]
    v_pk_fma_f32 v[98:99], v[94:95], v[144:145], v[98:99] op_sel_hi:[1,0,1]
    v_pk_fma_f32 v[100:101], v[92:93], v[146:147], v[100:101] op_sel_hi:[1,0,1]
    v_pk_fma_f32 v[102:103], v[94:95], v[146:147], v[102:103] op_sel_hi:[1,0,1]
    v_pk_fma_f32 v[104:105], v[92:93], v[148:149], v[104:105] op_sel_hi:[1,0,1]
    v_pk_fma_f32 v[106:107], v[94:95], v[148:149], v[106:107] op_sel_hi:[1,0,1]
    v_pk_fma_f32 v[108:109], v[92:93], v[150:151], v[108:109] op_sel_hi:[1,0,1]
    v_pk_fma_f32 v[110:111], v[94:95], v[150:151], v[110:111] op_sel_hi:[1,0,1]
    v_pk_mul_f32 v[96:97], v[96:97], v[144:145] op_sel:[0,1] op_sel_hi:[1,1]
    v_pk_mul_f32 v[98:99], v[98:99], v[144:145] op_sel:[0,1] op_sel_hi:[1,1]
    v_pk_mul_f32 v[100:101], v[100:101], v[146:147] op_sel:[0,1] op_sel_hi:[1,1]
    v_pk_mul_f32 v[102:103], v[102:103], v[146:147] op_sel:[0,1] op_sel_hi:[1,1]
    v_pk_mul_f32 v[104:105], v[104:105], v[148:149] op_sel:[0,1] op_sel_hi:[1,1]
    v_pk_mul_f32 v[106:107], v[106:107], v[148:149] op_sel:[0,1] op_sel_hi:[1,1]
    v_pk_mul_f32 v[108:109], v[108:109], v[150:151] op_sel:[0,1] op_sel_hi:[1,1]
    v_pk_mul_f32 v[110:111], v[110:111], v[150:151] op_sel:[0,1] op_sel_hi:[1,1]
    v_pk_mul_f32 v[112:113], v[96:97], v[96:97]
    v_pk_mul_f32 v[114:115], v[98:99], v[98:99]
    v_pk_mul_f32 v[116:117], v[100:101], v[100:101]
    v_pk_mul_f32 v[118:119], v[102:103], v[102:103]
    v_pk_mul_f32 v[120:121], v[104:105], v[104:105]
    v_pk_mul_f32 v[122:123], v[106:107], v[106:107]
    v_pk_mul_f32 v[124:125], v[108:109], v[108:109]
    v_pk_mul_f32 v[126:127], v[110:111], v[110:111]
    v_pk_fma_f32 v[112:113], v[112:113], v[20:21], v[20:21] op_sel:[0,1,0] op_sel_hi:[1,1,0]
    v_pk_fma_f32 v[114:115], v[114:115], v[20:21], v[20:21] op_sel:[0,1,0] op_sel_hi:[1,1,0]
    v_pk_fma_f32 v[116:117], v[116:117], v[20:21], v[20:21] op_sel:[0,1,0] op_sel_hi:[1,1,0]
    v_pk_fma_f32 v[118:119], v[118:119], v[20:21], v[20:21] op_sel:[0,1,0] op_sel_hi:[1,1,0]
    v_pk_fma_f32 v[120:121], v[120:121], v[20:21], v[20:21] op_sel:[0,1,0] op_sel_hi:[1,1,0]
    v_pk_fma_f32 v[122:123], v[122:123], v[20:21], v[20:21] op_sel:[0,1,0] op_sel_hi:[1,1,0]
    v_pk_fma_f32 v[124:125], v[124:125], v[20:21], v[20:21] op_sel:[0,1,0] op_sel_hi:[1,1,0]
    v_pk_fma_f32 v[126:127], v[126:127], v[20:21], v[20:21] op_sel:[0,1,0] op_sel_hi:[1,1,0]
    v_pk_mul_f32 v[112:113], v[112:113], v[96:97]
    v_pk_mul_f32 v[114:115], v[114:115], v[98:99]
    v_pk_mul_f32 v[116:117], v[116:117], v[100:101]
    v_pk_mul_f32 v[118:119], v[118:119], v[102:103]
    v_pk_mul_f32 v[120:121], v[120:121], v[104:105]
    v_pk_mul_f32 v[122:123], v[122:123], v[106:107]
    v_pk_mul_f32 v[124:125], v[124:125], v[108:109]
    v_pk_mul_f32 v[126:127], v[126:127], v[110:111]
    v_exp_f32 v112, v112
    v_exp_f32 v113, v113
    v_exp_f32 v114, v114
    v_exp_f32 v115, v115
    v_exp_f32 v116, v116
    v_exp_f32 v117, v117
    v_exp_f32 v118, v118
    v_exp_f32 v119, v119
    v_exp_f32 v120, v120
    v_exp_f32 v121, v121
    v_exp_f32 v122, v122
    v_exp_f32 v123, v123
    v_exp_f32 v124, v124
    v_exp_f32 v125, v125
    v_exp_f32 v126, v126
    v_exp_f32 v127, v127
    v_pk_add_f32 v[112:113], v[112:113], v[22:23] op_sel_hi:[1,0]
    v_pk_add_f32 v[114:115], v[114:115], v[22:23] op_sel_hi:[1,0]
    v_pk_add_f32 v[116:117], v[116:117], v[22:23] op_sel_hi:[1,0]
    v_pk_add_f32 v[118:119], v[118:119], v[22:23] op_sel_hi:[1,0]
    v_pk_add_f32 v[120:121], v[120:121], v[22:23] op_sel_hi:[1,0]
    v_pk_add_f32 v[122:123], v[122:123], v[22:23] op_sel_hi:[1,0]
    v_pk_add_f32 v[124:125], v[124:125], v[22:23] op_sel_hi:[1,0]
    v_pk_add_f32 v[126:127], v[126:127], v[22:23] op_sel_hi:[1,0]
    v_rcp_f32 v112, v112
    v_rcp_f32 v113, v113
    v_rcp_f32 v114, v114
    v_rcp_f32 v115, v115
    v_rcp_f32 v116, v116
    v_rcp_f32 v117, v117
    v_rcp_f32 v118, v118
    v_rcp_f32 v119, v119
    v_rcp_f32 v120, v120
    v_rcp_f32 v121, v121
    v_rcp_f32 v122, v122
    v_rcp_f32 v123, v123
    v_rcp_f32 v124, v124
    v_rcp_f32 v125, v125
    v_rcp_f32 v126, v126
    v_rcp_f32 v127, v127
    v_pk_mul_f32 v[96:97], v[96:97], v[112:113]
    v_pk_mul_f32 v[98:99], v[98:99], v[114:115]
    v_pk_mul_f32 v[100:101], v[100:101], v[116:117]
    v_pk_mul_f32 v[102:103], v[102:103], v[118:119]
    v_pk_mul_f32 v[104:105], v[104:105], v[120:121]
    v_pk_mul_f32 v[106:107], v[106:107], v[122:123]
    v_pk_mul_f32 v[108:109], v[108:109], v[124:125]
    v_pk_mul_f32 v[110:111], v[110:111], v[126:127]
    v_cvt_pk_bf16_f32 v160, v96, v97
    v_cvt_pk_bf16_f32 v162, v100, v101
    v_cvt_pk_bf16_f32 v161, v98, v99
    v_cvt_pk_bf16_f32 v163, v102, v103
    v_cvt_pk_bf16_f32 v164, v104, v105
    v_cvt_pk_bf16_f32 v166, v108, v109
    v_cvt_pk_bf16_f32 v165, v106, v107
    v_cvt_pk_bf16_f32 v167, v110, v111
    v_permlane32_swap_b32 v160, v162
    v_permlane32_swap_b32 v161, v163
    buffer_store_dwordx4 v[160:163], v18, s[40:43], s8 offen
    v_permlane32_swap_b32 v164, v166
    v_permlane32_swap_b32 v165, v167
    buffer_store_dwordx4 v[164:167], v18, s[40:43], s10 offen
    s_barrier
    s_waitcnt vmcnt(0)
    buffer_store_dword v3, v8, s[44:47], s9 offen offset:0
    s_barrier
    ds_read_b64_tr_b16 v[144:145], v13 offset:5120
    ds_read_b64_tr_b16 v[146:147], v13 offset:9216
    ds_read_b64_tr_b16 v[148:149], v13 offset:7168
    ds_read_b64_tr_b16 v[150:151], v13 offset:11264
    ds_read_b64_tr_b16 v[152:153], v13 offset:13312
    ds_read_b64_tr_b16 v[154:155], v13 offset:17408
    ds_read_b64_tr_b16 v[156:157], v13 offset:15360
    ds_read_b64_tr_b16 v[158:159], v13 offset:19456
    ds_read_b64_tr_b16 v[160:161], v13 offset:21504
    ds_read_b64_tr_b16 v[162:163], v13 offset:25600
    ds_read_b64_tr_b16 v[164:165], v13 offset:23552
    ds_read_b64_tr_b16 v[166:167], v13 offset:27648
    ds_read_b64_tr_b16 v[168:169], v13 offset:29696
    ds_read_b64_tr_b16 v[170:171], v13 offset:33792
    ds_read_b64_tr_b16 v[172:173], v13 offset:31744
    ds_read_b64_tr_b16 v[174:175], v13 offset:35840
    ds_read_b64_tr_b16 v[176:177], v13 offset:37888
    ds_read_b64_tr_b16 v[178:179], v13 offset:41984
    ds_read_b64_tr_b16 v[180:181], v13 offset:39936
    ds_read_b64_tr_b16 v[182:183], v13 offset:44032
    ds_read_b64_tr_b16 v[184:185], v12 offset:0
    ds_read_b64_tr_b16 v[186:187], v12 offset:4096
    ds_read_b64_tr_b16 v[188:189], v12 offset:2048
    ds_read_b64_tr_b16 v[190:191], v12 offset:6144
    v_xor_b32 v20, v5, v0
    v_and_b32 v20, 1, v20
    v_add_u32 v20, -1, v20
    v_and_b32 v104, 0x3f803f80, v20
    v_and_b32 v105, 0x3f803f80, v20
    v_and_b32 v106, 0x3f803f80, v20
    v_and_b32 v107, 0x3f803f80, v20
    s_waitcnt lgkmcnt(14)
    s_nop 0
    v_mfma_f32_16x16x32_bf16 v[40:43], v[104:107], v[144:147], 0
    v_mfma_f32_16x16x32_bf16 v[40:43], v[104:107], v[148:151], v[40:43]
    v_mfma_f32_16x16x32_bf16 v[40:43], v[104:107], v[152:155], v[40:43]
    v_mfma_f32_16x16x32_bf16 v[40:43], v[104:107], v[156:159], v[40:43]
    v_mfma_f32_16x16x32_bf16 v[40:43], v[104:107], v[160:163], v[40:43]
    s_waitcnt lgkmcnt(12)
    v_mfma_f32_16x16x32_bf16 v[40:43], v[104:107], v[164:167], v[40:43]
    s_waitcnt lgkmcnt(10)
    v_mfma_f32_16x16x32_bf16 v[40:43], v[104:107], v[168:171], v[40:43]
    s_waitcnt lgkmcnt(8)
    v_mfma_f32_16x16x32_bf16 v[40:43], v[104:107], v[172:175], v[40:43]
    s_waitcnt lgkmcnt(6)
    v_mfma_f32_16x16x32_bf16 v[40:43], v[104:107], v[176:179], v[40:43]
    s_waitcnt lgkmcnt(4)
    v_mfma_f32_16x16x32_bf16 v[40:43], v[104:107], v[180:183], v[40:43]
    s_waitcnt lgkmcnt(2)
    v_mfma_f32_16x16x32_bf16 v[40:43], v[104:107], v[184:187], v[40:43]
    s_waitcnt lgkmcnt(0)
    v_mfma_f32_16x16x32_bf16 v[40:43], v[104:107], v[188:191], v[40:43]
    v_add_u32 v10, 62464, v1
    v_lshlrev_b32 v14, 3, v0
    v_add_u32 v15, 159744, v14
    v_add_u32 v14, 57344, v14
    v_lshrrev_b32 v20, 2, v7
    v_and_b32 v21, 1, v7
    v_lshl_add_u32 v20, v20, 1, v21
    v_lshlrev_b32 v20, 10, v20
    v_and_b32 v21, 2, v7
    v_lshl_add_u32 v20, v21, 2, v20
    v_lshl_add_u32 v20, v6, 4, v20
    s_lshl_b32 s4, s48, 7
    s_lshl_b32 s5, s49, 12
    s_add_u32 s4, s4, s5
    v_add_u32 v16, s4, v20
    s_mul_i32 s8, s48, 14336
    s_lshl_b32 s5, s49, 10
    s_add_u32 s8, s8, s5
    s_add_u32 s8, s8, s54
    s_mul_i32 s5, s50, 57344
    s_sub_u32 s5, s5, s54
    s_add_u32 s14, s8, s5
    s_add_u32 s15, s8, 122880
    s_add_u32 s16, s8, 180224
    s_add_u32 s18, s8, 237568
    s_lshl_b32 s9, s48, 7
    s_lshl_b32 s5, s49, 2
    s_add_u32 s9, s9, s5
    s_add_u32 s9, s9, s54
    s_lshl2_add_u32 s4, s49, s48
    s_lshl_b32 s4, s4, 5
    s_add_u32 s12, s4, s54
    s_add_u32 s13, s4, s55
    s_lshl3_add_u32 s7, s51, s48
    s_mul_i32 s7, s7, 56
    s_add_u32 s7, s7, s49
    s_lshl_b32 s7, s7, 7
    s_lshl3_add_u32 s17, s50, s48
    s_mul_i32 s17, s17, 56
    s_add_u32 s17, s17, s49
    s_lshl_b32 s17, s17, 7
    s_barrier
    ds_read_b64_tr_b16 v[192:193], v12 offset:8192
    ds_read_b64_tr_b16 v[194:195], v12 offset:12288
    ds_read_b64_tr_b16 v[196:197], v12 offset:10240
    ds_read_b64_tr_b16 v[198:199], v12 offset:14336
    ds_read_b64_tr_b16 v[200:201], v12 offset:16384
    ds_read_b64_tr_b16 v[202:203], v12 offset:20480
    ds_read_b64_tr_b16 v[204:205], v12 offset:18432
    ds_read_b64_tr_b16 v[206:207], v12 offset:22528
    ds_read_b64_tr_b16 v[208:209], v12 offset:24576
    ds_read_b64_tr_b16 v[210:211], v12 offset:28672
    ds_read_b64_tr_b16 v[212:213], v12 offset:26624
    ds_read_b64_tr_b16 v[214:215], v12 offset:30720
    ds_read_b64_tr_b16 v[216:217], v12 offset:32768
    ds_read_b64_tr_b16 v[218:219], v12 offset:36864
    ds_read_b64_tr_b16 v[220:221], v12 offset:34816
    ds_read_b64_tr_b16 v[222:223], v12 offset:38912
    ds_read_b64_tr_b16 v[224:225], v12 offset:40960
    ds_read_b64_tr_b16 v[226:227], v12 offset:45056
    ds_read_b64_tr_b16 v[228:229], v12 offset:43008
    ds_read_b64_tr_b16 v[230:231], v12 offset:47104
    ds_read_b64_tr_b16 v[232:233], v12 offset:49152
    ds_read_b64_tr_b16 v[234:235], v12 offset:53248
    ds_read_b64_tr_b16 v[236:237], v12 offset:51200
    ds_read_b64_tr_b16 v[238:239], v12 offset:55296
    ds_read_b64_tr_b16 v[240:241], v13 offset:46080
    ds_read_b64_tr_b16 v[242:243], v13 offset:50176
    ds_read_b64_tr_b16 v[244:245], v13 offset:48128
    ds_read_b64_tr_b16 v[246:247], v13 offset:52224
    ds_read_b64_tr_b16 v[248:249], v13 offset:54272
    ds_read_b64_tr_b16 v[250:251], v13 offset:58368
    ds_read_b64_tr_b16 v[252:253], v13 offset:56320
    ds_read_b64_tr_b16 v[254:255], v13 offset:60416
    s_waitcnt lgkmcnt(14)
    v_mfma_f32_16x16x32_bf16 v[40:43], v[104:107], v[192:195], v[40:43]
    v_mfma_f32_16x16x32_bf16 v[40:43], v[104:107], v[196:199], v[40:43]
    v_mfma_f32_16x16x32_bf16 v[40:43], v[104:107], v[200:203], v[40:43]
    v_mfma_f32_16x16x32_bf16 v[40:43], v[104:107], v[204:207], v[40:43]
    v_mfma_f32_16x16x32_bf16 v[40:43], v[104:107], v[208:211], v[40:43]
    v_mfma_f32_16x16x32_bf16 v[40:43], v[104:107], v[212:215], v[40:43]
    v_mfma_f32_16x16x32_bf16 v[40:43], v[104:107], v[216:219], v[40:43]
    v_mfma_f32_16x16x32_bf16 v[40:43], v[104:107], v[220:223], v[40:43]
    v_mfma_f32_16x16x32_bf16 v[40:43], v[104:107], v[224:227], v[40:43]
    s_waitcnt lgkmcnt(12)
    v_mfma_f32_16x16x32_bf16 v[40:43], v[104:107], v[228:231], v[40:43]
    s_waitcnt lgkmcnt(10)
    v_mfma_f32_16x16x32_bf16 v[40:43], v[104:107], v[232:235], v[40:43]
    s_waitcnt lgkmcnt(8)
    v_mfma_f32_16x16x32_bf16 v[40:43], v[104:107], v[236:239], v[40:43]
    s_waitcnt lgkmcnt(6)
    v_mfma_f32_16x16x32_bf16 v[40:43], v[104:107], v[240:243], v[40:43]
    s_waitcnt lgkmcnt(4)
    v_mfma_f32_16x16x32_bf16 v[40:43], v[104:107], v[244:247], v[40:43]
    s_waitcnt lgkmcnt(2)
    v_mfma_f32_16x16x32_bf16 v[40:43], v[104:107], v[248:251], v[40:43]
    s_waitcnt lgkmcnt(0)
    v_mfma_f32_16x16x32_bf16 v[40:43], v[104:107], v[252:255], v[40:43]
    v_cmp_eq_u32 vcc, 1, v5
    s_nop 6
    v_cndmask_b32 v40, v40, v41, vcc
    v_cvt_pk_bf16_f32 v20, v40, v40
    v_and_b32 v21, 0xffff0000, v20
    v_sub_f32 v21, v40, v21
    v_cmp_gt_u32 vcc, 32, v0
    v_cvt_pk_bf16_f32 v20, v40, v21
    s_nop 0
    v_cndmask_b32 v18, 0, v20, vcc
    v_mov_b32 v19, v18
    s_setprio 2
    s_barrier
    ds_read_b128 v[56:59], v10 offset:0
    ds_read_b128 v[60:63], v10 offset:1024
    ds_read_b128 v[64:67], v10 offset:2048
    ds_read_b128 v[68:71], v10 offset:3072
    ds_read_b128 v[72:75], v10 offset:4096
    ds_read_b128 v[76:79], v10 offset:5120
    ds_read_b128 v[80:83], v10 offset:6144
    ds_read_b128 v[84:87], v10 offset:7168
    v_add_u32 v11, 7168, v1
    s_waitcnt lgkmcnt(7)
    v_mfma_f32_32x32x16_bf16 v[24:39], v[144:147], v[56:59], 0
    ds_read_b128 v[88:91], v10 offset:8192
    ds_read_b64 v[104:105], v14 offset:0
    ds_read_b64 v[106:107], v14 offset:512
    ds_read_b64 v[108:109], v14 offset:1024
    ds_read_b64 v[110:111], v14 offset:1536
    s_waitcnt lgkmcnt(11)
    v_mfma_f32_32x32x16_bf16 v[24:39], v[148:151], v[60:63], v[24:39]
    ds_read_b128 v[92:95], v10 offset:9216
    ds_read_b64 v[40:41], v14 offset:4096
    ds_read_b64 v[42:43], v14 offset:4608
    ds_read_b64 v[44:45], v15 offset:1024
    ds_read_b64 v[46:47], v15 offset:1536
    s_waitcnt lgkmcnt(14)
    v_mfma_f32_32x32x16_bf16 v[24:39], v[152:155], v[64:67], v[24:39]
    ds_read_b128 v[96:99], v10 offset:10240
    ds_read_b64 v[112:113], v14 offset:2048
    ds_read_b64 v[114:115], v14 offset:2560
    ds_read_b64 v[116:117], v14 offset:3072
    v_mfma_f32_32x32x16_bf16 v[24:39], v[156:159], v[68:71], v[24:39]
    ds_read_b128 v[56:59], v10 offset:11264
    ds_read_b64 v[48:49], v15 offset:2048
    ds_read_b64 v[50:51], v15 offset:2560
    ds_read_b64 v[52:53], v15 offset:3072
    s_waitcnt lgkmcnt(14)
    v_mfma_f32_32x32x16_bf16 v[24:39], v[160:163], v[72:75], v[24:39]
    ds_read_b128 v[60:63], v10 offset:12288
    v_mfma_f32_32x32x16_bf16 v[24:39], v[164:167], v[76:79], v[24:39]
    ds_read_b128 v[20:23], v9 offset:0
    ds_read_b128 v[64:67], v10 offset:13312
    v_mfma_f32_32x32x16_bf16 v[24:39], v[168:171], v[80:83], v[24:39]
    ds_read_b128 v[68:71], v10 offset:14336
    v_add_f32 v104, v104, v106
    s_waitcnt lgkmcnt(14)
    v_add_f32 v40, v40, v42
    v_add_f32 v105, v105, v107
    v_add_f32 v41, v41, v43
    v_add_f32 v104, v104, v108
    v_mfma_f32_32x32x16_bf16 v[24:39], v[172:175], v[84:87], v[24:39]
    ds_read_b128 v[72:75], v10 offset:15360
    s_waitcnt lgkmcnt(14)
    v_add_f32 v40, v40, v44
    v_add_f32 v105, v105, v109
    v_add_f32 v41, v41, v45
    v_add_f32 v104, v104, v110
    s_waitcnt lgkmcnt(13)
    v_add_f32 v40, v40, v46
    s_waitcnt lgkmcnt(8)
    v_mfma_f32_32x32x16_bf16 v[24:39], v[176:179], v[88:91], v[24:39]
    s_waitcnt lgkmcnt(3)
    v_min3_u32 v20, v20, v21, v22
    v_min_u32 v20, v20, v23
    v_cmp_ne_u32 vcc, s53, v20
    s_cbranch_vccnz Lslow4_2
Lback_3:
    ds_read_b128 v[76:79], v10 offset:16384
    v_mfma_f32_32x32x16_bf16 v[24:39], v[180:183], v[92:95], v[24:39]
    ds_read_b128 v[80:83], v10 offset:17408
    v_add_f32 v105, v105, v111
    v_add_f32 v41, v41, v47
    v_add_f32 v104, v104, v112
    v_add_f32 v40, v40, v48
    v_add_f32 v105, v105, v113
    v_mfma_f32_32x32x16_bf16 v[24:39], v[184:187], v[96:99], v[24:39]
    ds_read_b128 v[84:87], v10 offset:18432
    v_add_f32 v41, v41, v49
    v_add_f32 v104, v104, v114
    v_add_f32 v40, v40, v50
    v_add_f32 v105, v105, v115
    v_add_f32 v41, v41, v51
    v_mfma_f32_32x32x16_bf16 v[24:39], v[188:191], v[56:59], v[24:39]
    ds_read_b128 v[88:91], v10 offset:19456
    v_add_f32 v104, v104, v116
    v_add_f32 v40, v40, v52
    v_add_f32 v105, v105, v117
    v_add_f32 v41, v41, v53
    s_waitcnt lgkmcnt(4)
    v_mfma_f32_32x32x16_bf16 v[24:39], v[192:195], v[60:63], v[24:39]
    ds_read_b128 v[92:95], v10 offset:20480
    v_mul_f32 v104, 0xbb124925, v104
    v_mul_f32 v40, 0xbb124925, v40
    v_mul_f32 v105, 0x3b124925, v105
    v_mul_f32 v41, 0x3b124925, v41
    v_mfma_f32_32x32x16_bf16 v[24:39], v[196:199], v[64:67], v[24:39]
    ds_read_b128 v[96:99], v10 offset:21504
    v_cvt_pk_bf16_f32 v124, v104, v104
    v_cvt_pk_bf16_f32 v128, v40, v40
    v_fma_f32 v105, -v104, v104, v105
    v_fma_f32 v41, -v40, v40, v41
    v_max_f32 v105, 0, v105
    v_mfma_f32_32x32x16_bf16 v[24:39], v[200:203], v[68:71], v[24:39]
    ds_read_b128 v[56:59], v10 offset:22528
    v_max_f32 v41, 0, v41
    v_cvt_pk_bf16_f32 v105, v105, v105
    v_cvt_pk_bf16_f32 v41, v41, v41
    v_and_b32 v105, 0xffff0000, v105
    v_and_b32 v41, 0xffff0000, v41
    v_mfma_f32_32x32x16_bf16 v[24:39], v[204:207], v[72:75], v[24:39]
    ds_read_b128 v[60:63], v10 offset:23552
    v_add_f32 v105, 0x3727c5ac, v105
    v_add_f32 v41, 0x3727c5ac, v41
    v_cvt_pk_bf16_f32 v105, v105, v105
    v_cvt_pk_bf16_f32 v41, v41, v41
    v_and_b32 v105, 0xffff0000, v105
    s_waitcnt lgkmcnt(4)
    v_mfma_f32_32x32x16_bf16 v[24:39], v[208:211], v[76:79], v[24:39]
    ds_read_b128 v[64:67], v10 offset:24576
    v_and_b32 v41, 0xffff0000, v41
    v_sqrt_f32 v134, v105
    v_mfma_f32_32x32x16_bf16 v[24:39], v[212:215], v[80:83], v[24:39]
    ds_read_b128 v[20:23], v9 offset:16
    ds_read_b128 v[68:71], v10 offset:25600
    v_sqrt_f32 v140, v41
    v_mov_b32 v125, 0
    v_mov_b32 v129, 0
    v_mov_b32 v127, 0
    v_mfma_f32_32x32x16_bf16 v[24:39], v[216:219], v[84:87], v[24:39]
    ds_read_b128 v[72:75], v10 offset:26624
    v_mov_b32 v131, 0
    v_cvt_pk_bf16_f32 v134, v134, v134
    v_cvt_pk_bf16_f32 v140, v140, v140
    v_and_b32 v134, 0xffff0000, v134
    v_and_b32 v140, 0xffff0000, v140
    v_mfma_f32_32x32x16_bf16 v[24:39], v[220:223], v[88:91], v[24:39]
    ds_read_b128 v[76:79], v10 offset:27648
    v_rcp_f32 v106, v134
    v_rcp_f32 v42, v140
    v_mov_b32 v126, v124
    s_waitcnt lgkmcnt(5)
    v_mfma_f32_32x32x16_bf16 v[24:39], v[224:227], v[92:95], v[24:39]
    s_waitcnt lgkmcnt(3)
    v_min3_u32 v20, v20, v21, v22
    v_min_u32 v20, v20, v23
    v_cmp_ne_u32 vcc, s53, v20
    s_cbranch_vccnz Lslow4_4
Lback_5:
    ds_read_b128 v[80:83], v10 offset:28672
    v_mfma_f32_32x32x16_bf16 v[24:39], v[228:231], v[96:99], v[24:39]
    ds_read_b128 v[84:87], v10 offset:29696
    v_mov_b32 v130, v128
    v_mul_f32 v132, 0xc0135761, v106
    v_mul_f32 v138, 0xc0135761, v42
    v_mul_f32 v107, v106, v106
    v_mfma_f32_32x32x16_bf16 v[24:39], v[232:235], v[56:59], v[24:39]
    ds_read_b128 v[88:91], v10 offset:30720
    v_mul_f32 v43, v42, v42
    v_mul_f32 v107, 0x3d372713, v107
    v_mul_f32 v43, 0x3d372713, v43
    v_mov_b32 v135, v132
    v_mov_b32 v141, v138
    v_mfma_f32_32x32x16_bf16 v[24:39], v[236:239], v[60:63], v[24:39]
    ds_read_b128 v[92:95], v10 offset:31744
    v_mov_b32 v137, v134
    v_mov_b32 v143, v140
    v_mul_f32 v133, v107, v132
    v_mul_f32 v139, v43, v138
    v_permlane32_swap_b32 v124, v126
    s_waitcnt lgkmcnt(4)
    v_mfma_f32_32x32x16_bf16 v[24:39], v[240:243], v[64:67], v[24:39]
    ds_read_b128 v[96:99], v10 offset:32768
    v_permlane32_swap_b32 v128, v130
    v_mov_b32 v136, v133
    v_mov_b32 v142, v139
    v_permlane32_swap_b32 v132, v135
    v_mfma_f32_32x32x16_bf16 v[24:39], v[244:247], v[68:71], v[24:39]
    ds_read_b128 v[56:59], v10 offset:33792
    v_permlane32_swap_b32 v138, v141
    v_permlane32_swap_b32 v134, v137
    v_permlane32_swap_b32 v140, v143
    v_permlane32_swap_b32 v133, v136
    v_permlane32_swap_b32 v139, v142
    v_mfma_f32_32x32x16_bf16 v[24:39], v[248:251], v[72:75], v[24:39]
    ds_read_b128 v[60:63], v10 offset:34816
    v_mfma_f32_32x32x8_bf16 v[24:39], v[18:19], v[124:125], v[24:39]
    v_mfma_f32_32x32x16_bf16 v[24:39], v[252:255], v[76:79], v[24:39]
    ds_read_b128 v[64:67], v10 offset:35840
    s_waitcnt lgkmcnt(4)
    v_mfma_f32_32x32x16_bf16 v[40:55], v[144:147], v[80:83], 0
    ds_read_b128 v[68:71], v10 offset:36864
    v_mfma_f32_32x32x16_bf16 v[40:55], v[148:151], v[84:87], v[40:55]
    ds_read_b128 v[72:75], v10 offset:37888
    v_mfma_f32_32x32x16_bf16 v[40:55], v[152:155], v[88:91], v[40:55]
    ds_read_b128 v[76:79], v10 offset:38912
    s_nop 3
    v_mul_f32 v104, v24, v24
    v_mul_f32 v105, v25, v25
    v_mul_f32 v106, v26, v26
    v_mul_f32 v107, v27, v27
    v_mul_f32 v108, v28, v28
    v_mul_f32 v109, v29, v29
    v_mfma_f32_32x32x8_bf16 v[40:55], v[18:19], v[126:127], v[40:55]
    v_mul_f32 v110, v30, v30
    v_mul_f32 v111, v31, v31
    v_fma_f32 v104, v104, v133, v132
    v_fma_f32 v105, v105, v133, v132
    v_fma_f32 v106, v106, v133, v132
    v_fma_f32 v107, v107, v133, v132
    v_fma_f32 v108, v108, v133, v132
    v_mfma_f32_32x32x16_bf16 v[40:55], v[156:159], v[92:95], v[40:55]
    ds_read_b128 v[80:83], v10 offset:39936
    v_fma_f32 v109, v109, v133, v132
    v_fma_f32 v110, v110, v133, v132
    v_fma_f32 v111, v111, v133, v132
    v_mul_f32 v104, v104, v24
    v_mul_f32 v105, v105, v25
    v_mul_f32 v106, v106, v26
    s_waitcnt lgkmcnt(4)
    v_mfma_f32_32x32x16_bf16 v[40:55], v[160:163], v[96:99], v[40:55]
    ds_read_b128 v[84:87], v10 offset:40960
    v_mul_f32 v107, v107, v27
    v_mul_f32 v108, v108, v28
    v_mul_f32 v109, v109, v29
    v_mul_f32 v110, v110, v30
    v_mul_f32 v111, v111, v31
    v_mfma_f32_32x32x16_bf16 v[40:55], v[164:167], v[56:59], v[40:55]
    ds_read_b128 v[88:91], v10 offset:41984
    v_exp_f32 v104, v104
    v_exp_f32 v105, v105
    v_exp_f32 v106, v106
    v_mfma_f32_32x32x16_bf16 v[40:55], v[168:171], v[60:63], v[40:55]
    ds_read_b128 v[92:95], v10 offset:43008
    v_exp_f32 v107, v107
    v_exp_f32 v108, v108
    v_exp_f32 v109, v109
    v_mfma_f32_32x32x16_bf16 v[40:55], v[172:175], v[64:67], v[40:55]
    ds_read_b128 v[96:99], v10 offset:44032
    v_exp_f32 v110, v110
    v_exp_f32 v111, v111
    v_fma_f32 v104, v104, v134, v134
    v_fma_f32 v105, v105, v134, v134
    v_fma_f32 v106, v106, v134, v134
    s_waitcnt lgkmcnt(4)
    v_mfma_f32_32x32x16_bf16 v[40:55], v[176:179], v[68:71], v[40:55]
    ds_read_b128 v[56:59], v10 offset:45056
    v_fma_f32 v107, v107, v134, v134
    v_fma_f32 v108, v108, v134, v134
    v_fma_f32 v109, v109, v134, v134
    v_fma_f32 v110, v110, v134, v134
    v_fma_f32 v111, v111, v134, v134
    v_mfma_f32_32x32x16_bf16 v[40:55], v[180:183], v[72:75], v[40:55]
    ds_read_b128 v[60:63], v10 offset:46080
    v_rcp_f32 v104, v104
    v_rcp_f32 v105, v105
    v_rcp_f32 v106, v106
    v_mfma_f32_32x32x16_bf16 v[40:55], v[184:187], v[76:79], v[40:55]
    ds_read_b128 v[64:67], v10 offset:47104
    v_rcp_f32 v107, v107
    v_rcp_f32 v108, v108
    v_rcp_f32 v109, v109
    v_mfma_f32_32x32x16_bf16 v[40:55], v[188:191], v[80:83], v[40:55]
    ds_read_b128 v[68:71], v10 offset:48128
    v_rcp_f32 v110, v110
    v_rcp_f32 v111, v111
    v_mul_f32 v104, v104, v24
    v_mul_f32 v105, v105, v25
    s_waitcnt lgkmcnt(4)
    v_mfma_f32_32x32x16_bf16 v[40:55], v[192:195], v[84:87], v[40:55]
    ds_read_b128 v[72:75], v10 offset:49152
    v_mul_f32 v106, v106, v26
    v_mul_f32 v107, v107, v27
    v_mul_f32 v108, v108, v28
    v_mul_f32 v109, v109, v29
    v_mul_f32 v110, v110, v30
    v_mfma_f32_32x32x16_bf16 v[40:55], v[196:199], v[88:91], v[40:55]
    ds_read_b128 v[76:79], v10 offset:50176
    v_mul_f32 v111, v111, v31
    v_cvt_pk_bf16_f32 v100, v104, v105
    v_cvt_pk_bf16_f32 v101, v106, v107
    v_cvt_pk_bf16_f32 v102, v108, v109
    v_cvt_pk_bf16_f32 v103, v110, v111
    v_mul_f32 v104, v32, v32
    v_mfma_f32_32x32x16_bf16 v[40:55], v[200:203], v[92:95], v[40:55]
    ds_read_b128 v[80:83], v10 offset:51200
    v_mul_f32 v105, v33, v33
    v_mul_f32 v106, v34, v34
    v_mul_f32 v107, v35, v35
    v_mul_f32 v108, v36, v36
    v_mul_f32 v109, v37, v37
    v_mul_f32 v110, v38, v38
    v_mfma_f32_32x32x16_bf16 v[40:55], v[204:207], v[96:99], v[40:55]
    ds_read_b128 v[84:87], v10 offset:52224
    v_mul_f32 v111, v39, v39
    v_fma_f32 v104, v104, v133, v132
    v_fma_f32 v105, v105, v133, v132
    v_fma_f32 v106, v106, v133, v132
    v_fma_f32 v107, v107, v133, v132
    v_fma_f32 v108, v108, v133, v132
    s_waitcnt lgkmcnt(4)
    v_mfma_f32_32x32x16_bf16 v[40:55], v[208:211], v[56:59], v[40:55]
    ds_read_b128 v[88:91], v10 offset:53248
    v_fma_f32 v109, v109, v133, v132
    v_fma_f32 v110, v110, v133, v132
    v_fma_f32 v111, v111, v133, v132
    v_mul_f32 v104, v104, v32
    v_mul_f32 v105, v105, v33
    v_mfma_f32_32x32x16_bf16 v[40:55], v[212:215], v[60:63], v[40:55]
    ds_read_b128 v[20:23], v9 offset:32
    ds_read_b128 v[92:95], v10 offset:54272
    v_mul_f32 v106, v106, v34
    v_mul_f32 v107, v107, v35
    v_mul_f32 v108, v108, v36
    v_mul_f32 v109, v109, v37
    v_mul_f32 v110, v110, v38
    v_mfma_f32_32x32x16_bf16 v[40:55], v[216:219], v[64:67], v[40:55]
    ds_read_b128 v[96:99], v10 offset:55296
    v_mul_f32 v111, v111, v39
    v_exp_f32 v104, v104
    v_exp_f32 v105, v105
    v_exp_f32 v106, v106
    v_mfma_f32_32x32x16_bf16 v[40:55], v[220:223], v[68:71], v[40:55]
    ds_read_b128 v[56:59], v10 offset:56320
    v_exp_f32 v107, v107
    v_exp_f32 v108, v108
    v_exp_f32 v109, v109
    s_waitcnt lgkmcnt(5)
    v_mfma_f32_32x32x16_bf16 v[40:55], v[224:227], v[72:75], v[40:55]
    s_waitcnt lgkmcnt(3)
    v_min3_u32 v20, v20, v21, v22
    v_min_u32 v20, v20, v23
    v_cmp_ne_u32 vcc, s53, v20
    s_cbranch_vccnz Lslow4_6
Lback_7:
    ds_read_b128 v[60:63], v1 offset:0
    v_mfma_f32_32x32x16_bf16 v[40:55], v[228:231], v[76:79], v[40:55]
    ds_read_b128 v[64:67], v1 offset:1024
    v_exp_f32 v110, v110
    v_exp_f32 v111, v111
    v_fma_f32 v104, v104, v134, v134
    v_fma_f32 v105, v105, v134, v134
    v_fma_f32 v106, v106, v134, v134
    v_mfma_f32_32x32x16_bf16 v[40:55], v[232:235], v[80:83], v[40:55]
    ds_read_b128 v[68:71], v1 offset:2048
    v_fma_f32 v107, v107, v134, v134
    v_fma_f32 v108, v108, v134, v134
    v_fma_f32 v109, v109, v134, v134
    v_fma_f32 v110, v110, v134, v134
    v_fma_f32 v111, v111, v134, v134
    v_mfma_f32_32x32x16_bf16 v[40:55], v[236:239], v[84:87], v[40:55]
    ds_read_b128 v[72:75], v1 offset:3072
    v_rcp_f32 v104, v104
    v_rcp_f32 v105, v105
    v_rcp_f32 v106, v106
    s_waitcnt lgkmcnt(4)
    v_mfma_f32_32x32x16_bf16 v[40:55], v[240:243], v[88:91], v[40:55]
    ds_read_b128 v[76:79], v1 offset:4096
    v_rcp_f32 v107, v107
    v_rcp_f32 v108, v108
    v_rcp_f32 v109, v109
    v_mfma_f32_32x32x16_bf16 v[40:55], v[244:247], v[92:95], v[40:55]
    ds_read_b128 v[80:83], v1 offset:5120
    v_rcp_f32 v110, v110
    v_rcp_f32 v111, v111
    v_mul_f32 v104, v104, v32
    v_mul_f32 v105, v105, v33
    v_mfma_f32_32x32x16_bf16 v[40:55], v[248:251], v[96:99], v[40:55]
    ds_read_b128 v[84:87], v1 offset:6144
    v_mul_f32 v106, v106, v34
    v_mul_f32 v107, v107, v35
    v_mul_f32 v108, v108, v36
    v_mul_f32 v109, v109, v37
    v_mul_f32 v110, v110, v38
    v_mul_f32 v111, v111, v39
    v_mfma_f32_32x32x16_bf16 v[40:55], v[252:255], v[56:59], v[40:55]
    ds_read_b128 v[88:91], v1 offset:7168
    v_cvt_pk_bf16_f32 v112, v104, v105
    v_cvt_pk_bf16_f32 v113, v106, v107
    v_cvt_pk_bf16_f32 v114, v108, v109
    v_cvt_pk_bf16_f32 v115, v110, v111
    buffer_store_dwordx4 v[100:103], v1, s[40:43], s14 offen
    buffer_store_dwordx4 v[112:115], v11, s[40:43], s14 offen
    s_waitcnt lgkmcnt(4)
    v_mfma_f32_32x32x16_bf16 v[24:39], v[144:147], v[60:63], 0
    ds_read_b128 v[92:95], v1 offset:8192
    v_mfma_f32_32x32x16_bf16 v[24:39], v[148:151], v[64:67], v[24:39]
    ds_read_b128 v[96:99], v1 offset:9216
    v_mfma_f32_32x32x16_bf16 v[24:39], v[152:155], v[68:71], v[24:39]
    ds_read_b128 v[56:59], v1 offset:10240
    v_mul_f32 v104, v40, v40
    v_mul_f32 v105, v41, v41
    v_mul_f32 v106, v42, v42
    v_mul_f32 v107, v43, v43
    v_mul_f32 v108, v44, v44
    v_mul_f32 v109, v45, v45
    v_mfma_f32_32x32x8_bf16 v[24:39], v[18:19], v[128:129], v[24:39]
    v_mul_f32 v110, v46, v46
    v_mul_f32 v111, v47, v47
    v_fma_f32 v104, v104, v136, v135
    v_fma_f32 v105, v105, v136, v135
    v_fma_f32 v106, v106, v136, v135
    v_fma_f32 v107, v107, v136, v135
    v_fma_f32 v108, v108, v136, v135
    v_fma_f32 v109, v109, v136, v135
    v_mfma_f32_32x32x16_bf16 v[24:39], v[156:159], v[72:75], v[24:39]
    ds_read_b128 v[60:63], v1 offset:11264
    v_fma_f32 v110, v110, v136, v135
    v_fma_f32 v111, v111, v136, v135
    v_mul_f32 v104, v104, v40
    v_mul_f32 v105, v105, v41
    v_mul_f32 v106, v106, v42
    v_mul_f32 v107, v107, v43
    s_waitcnt lgkmcnt(4)
    v_mfma_f32_32x32x16_bf16 v[24:39], v[160:163], v[76:79], v[24:39]
    ds_read_b128 v[64:67], v1 offset:12288
    v_mul_f32 v108, v108, v44
    v_mul_f32 v109, v109, v45
    v_mul_f32 v110, v110, v46
    v_mul_f32 v111, v111, v47
    v_exp_f32 v104, v104
    v_mfma_f32_32x32x16_bf16 v[24:39], v[164:167], v[80:83], v[24:39]
    ds_read_b128 v[68:71], v1 offset:13312
    v_exp_f32 v105, v105
    v_exp_f32 v106, v106
    v_exp_f32 v107, v107
    v_mfma_f32_32x32x16_bf16 v[24:39], v[168:171], v[84:87], v[24:39]
    ds_read_b128 v[72:75], v1 offset:14336
    v_exp_f32 v108, v108
    v_exp_f32 v109, v109
    v_exp_f32 v110, v110
    v_mfma_f32_32x32x16_bf16 v[24:39], v[172:175], v[88:91], v[24:39]
    ds_read_b128 v[76:79], v1 offset:15360
    v_exp_f32 v111, v111
    v_fma_f32 v104, v104, v137, v137
    v_fma_f32 v105, v105, v137, v137
    v_fma_f32 v106, v106, v137, v137
    v_fma_f32 v107, v107, v137, v137
    s_waitcnt lgkmcnt(4)
    v_mfma_f32_32x32x16_bf16 v[24:39], v[176:179], v[92:95], v[24:39]
    ds_read_b128 v[80:83], v1 offset:16384
    v_fma_f32 v108, v108, v137, v137
    v_fma_f32 v109, v109, v137, v137
    v_fma_f32 v110, v110, v137, v137
    v_fma_f32 v111, v111, v137, v137
    v_rcp_f32 v104, v104
    v_mfma_f32_32x32x16_bf16 v[24:39], v[180:183], v[96:99], v[24:39]
    ds_read_b128 v[84:87], v1 offset:17408
    v_rcp_f32 v105, v105
    v_rcp_f32 v106, v106
    v_rcp_f32 v107, v107
    v_mfma_f32_32x32x16_bf16 v[24:39], v[184:187], v[56:59], v[24:39]
    ds_read_b128 v[88:91], v1 offset:18432
    ds_read_b64 v[116:117], v16 offset:0
    ds_read_b64 v[118:119], v16 offset:512
    v_rcp_f32 v108, v108
    v_rcp_f32 v109, v109
    v_mfma_f32_32x32x16_bf16 v[24:39], v[188:191], v[60:63], v[24:39]
    ds_read_b128 v[92:95], v1 offset:19456
    v_rcp_f32 v110, v110
    v_rcp_f32 v111, v111
    v_mul_f32 v104, v104, v40
    v_mul_f32 v105, v105, v41
    s_waitcnt lgkmcnt(6)
    v_mfma_f32_32x32x16_bf16 v[24:39], v[192:195], v[64:67], v[24:39]
    ds_read_b128 v[96:99], v1 offset:20480
    v_mul_f32 v106, v106, v42
    v_mul_f32 v107, v107, v43
    v_mul_f32 v108, v108, v44
    v_mul_f32 v109, v109, v45
    v_mul_f32 v110, v110, v46
    v_mfma_f32_32x32x16_bf16 v[24:39], v[196:199], v[68:71], v[24:39]
    ds_read_b128 v[56:59], v1 offset:21504
    v_mul_f32 v111, v111, v47
    v_cvt_pk_bf16_f32 v100, v104, v105
    v_cvt_pk_bf16_f32 v101, v106, v107
    v_cvt_pk_bf16_f32 v102, v108, v109
    v_cvt_pk_bf16_f32 v103, v110, v111
    v_add_u32 v17, 2, v3
    v_mfma_f32_32x32x16_bf16 v[24:39], v[200:203], v[72:75], v[24:39]
    ds_read_b128 v[60:63], v1 offset:22528
    s_waitcnt vmcnt(0)
    buffer_store_dword v17, v8, s[44:47], s9 offen offset:512
    v_mul_f32 v104, v48, v48
    v_mul_f32 v105, v49, v49
    v_mul_f32 v106, v50, v50
    v_mul_f32 v107, v51, v51
    v_mul_f32 v108, v52, v52
    v_mfma_f32_32x32x16_bf16 v[24:39], v[204:207], v[76:79], v[24:39]
    ds_read_b128 v[64:67], v1 offset:23552
    v_mul_f32 v109, v53, v53
    v_mul_f32 v110, v54, v54
    v_mul_f32 v111, v55, v55
    v_fma_f32 v104, v104, v136, v135
    v_fma_f32 v105, v105, v136, v135
    v_fma_f32 v106, v106, v136, v135
    s_waitcnt lgkmcnt(4)
    v_mfma_f32_32x32x16_bf16 v[24:39], v[208:211], v[80:83], v[24:39]
    ds_read_b128 v[68:71], v1 offset:24576
    v_fma_f32 v107, v107, v136, v135
    v_fma_f32 v108, v108, v136, v135
    v_fma_f32 v109, v109, v136, v135
    v_fma_f32 v110, v110, v136, v135
    v_fma_f32 v111, v111, v136, v135
    v_mfma_f32_32x32x16_bf16 v[24:39], v[212:215], v[84:87], v[24:39]
    ds_read_b128 v[20:23], v9 offset:48
    ds_read_b128 v[72:75], v1 offset:25600
    v_mul_f32 v104, v104, v48
    v_mul_f32 v105, v105, v49
    v_mul_f32 v106, v106, v50
    v_mul_f32 v107, v107, v51
    v_mul_f32 v108, v108, v52
    v_mfma_f32_32x32x16_bf16 v[24:39], v[216:219], v[88:91], v[24:39]
    ds_read_b128 v[76:79], v1 offset:26624
    v_mul_f32 v109, v109, v53
    v_mul_f32 v110, v110, v54
    v_mul_f32 v111, v111, v55
    v_exp_f32 v104, v104
    v_exp_f32 v105, v105
    v_mfma_f32_32x32x16_bf16 v[24:39], v[220:223], v[92:95], v[24:39]
    ds_read_b128 v[80:83], v1 offset:27648
    v_exp_f32 v106, v106
    v_exp_f32 v107, v107
    v_exp_f32 v108, v108
    s_waitcnt lgkmcnt(5)
    v_mfma_f32_32x32x16_bf16 v[24:39], v[224:227], v[96:99], v[24:39]
    s_waitcnt lgkmcnt(3)
    v_min3_u32 v20, v20, v21, v22
    v_min_u32 v20, v20, v23
    v_cmp_ne_u32 vcc, s53, v20
    s_cbranch_vccnz Lslow4_8
Lback_9:
    ds_read_b128 v[84:87], v1 offset:28672
    v_exp_f32 v109, v109
    v_mfma_f32_32x32x16_bf16 v[24:39], v[228:231], v[56:59], v[24:39]
    ds_read_b128 v[88:91], v1 offset:29696
    v_exp_f32 v110, v110
    v_exp_f32 v111, v111
    v_fma_f32 v104, v104, v137, v137
    v_mfma_f32_32x32x16_bf16 v[24:39], v[232:235], v[60:63], v[24:39]
    ds_read_b128 v[92:95], v1 offset:30720
    v_fma_f32 v105, v105, v137, v137
    v_fma_f32 v106, v106, v137, v137
    v_fma_f32 v107, v107, v137, v137
    v_fma_f32 v108, v108, v137, v137
    v_fma_f32 v109, v109, v137, v137
    v_fma_f32 v110, v110, v137, v137
    v_fma_f32 v111, v111, v137, v137
    v_mfma_f32_32x32x16_bf16 v[24:39], v[236:239], v[64:67], v[24:39]
    ds_read_b128 v[96:99], v1 offset:31744
    v_rcp_f32 v104, v104
    v_rcp_f32 v105, v105
    v_rcp_f32 v106, v106
    s_waitcnt lgkmcnt(4)
    v_mfma_f32_32x32x16_bf16 v[24:39], v[240:243], v[68:71], v[24:39]
    ds_read_b128 v[56:59], v1 offset:32768
    v_rcp_f32 v107, v107
    v_rcp_f32 v108, v108
    v_rcp_f32 v109, v109
    v_mfma_f32_32x32x16_bf16 v[24:39], v[244:247], v[72:75], v[24:39]
    ds_read_b128 v[60:63], v1 offset:33792
    v_rcp_f32 v110, v110
    v_rcp_f32 v111, v111
    v_mul_f32 v104, v104, v48
    v_mfma_f32_32x32x16_bf16 v[24:39], v[248:251], v[76:79], v[24:39]
    ds_read_b128 v[64:67], v1 offset:34816
    v_mul_f32 v105, v105, v49
    v_mul_f32 v106, v106, v50
    v_mul_f32 v107, v107, v51
    v_mul_f32 v108, v108, v52
    v_mul_f32 v109, v109, v53
    v_mul_f32 v110, v110, v54
    v_mul_f32 v111, v111, v55
    v_mfma_f32_32x32x16_bf16 v[24:39], v[252:255], v[80:83], v[24:39]
    ds_read_b128 v[68:71], v1 offset:35840
    v_cvt_pk_bf16_f32 v112, v104, v105
    v_cvt_pk_bf16_f32 v113, v106, v107
    v_cvt_pk_bf16_f32 v114, v108, v109
    v_cvt_pk_bf16_f32 v115, v110, v111
    buffer_store_dwordx4 v[100:103], v1, s[44:47], s15 offen sc1
    buffer_store_dwordx4 v[112:115], v11, s[44:47], s15 offen sc1
    s_waitcnt lgkmcnt(4)
    v_mfma_f32_32x32x16_bf16 v[40:55], v[144:147], v[84:87], 0
    ds_read_b128 v[72:75], v1 offset:36864
    v_mfma_f32_32x32x16_bf16 v[40:55], v[148:151], v[88:91], v[40:55]
    ds_read_b128 v[76:79], v1 offset:37888
    v_mfma_f32_32x32x16_bf16 v[40:55], v[152:155], v[92:95], v[40:55]
    ds_read_b128 v[80:83], v1 offset:38912
    v_mul_f32 v104, v24, v24
    v_mul_f32 v105, v25, v25
    v_mul_f32 v106, v26, v26
    v_mul_f32 v107, v27, v27
    v_mul_f32 v108, v28, v28
    v_mul_f32 v109, v29, v29
    v_mfma_f32_32x32x8_bf16 v[40:55], v[18:19], v[130:131], v[40:55]
    v_mul_f32 v110, v30, v30
    v_mul_f32 v111, v31, v31
    v_fma_f32 v104, v104, v139, v138
    v_fma_f32 v105, v105, v139, v138
    v_fma_f32 v106, v106, v139, v138
    v_fma_f32 v107, v107, v139, v138
    v_fma_f32 v108, v108, v139, v138
    v_mfma_f32_32x32x16_bf16 v[40:55], v[156:159], v[96:99], v[40:55]
    ds_read_b128 v[84:87], v1 offset:39936
    v_fma_f32 v109, v109, v139, v138
    v_fma_f32 v110, v110, v139, v138
    v_fma_f32 v111, v111, v139, v138
    v_mul_f32 v104, v104, v24
    v_mul_f32 v105, v105, v25
    s_waitcnt lgkmcnt(4)
    v_mfma_f32_32x32x16_bf16 v[40:55], v[160:163], v[56:59], v[40:55]
    ds_read_b128 v[88:91], v1 offset:40960
    v_mul_f32 v106, v106, v26
    v_mul_f32 v107, v107, v27
    v_mul_f32 v108, v108, v28
    v_mul_f32 v109, v109, v29
    v_mul_f32 v110, v110, v30
    v_mfma_f32_32x32x16_bf16 v[40:55], v[164:167], v[60:63], v[40:55]
    ds_read_b128 v[92:95], v1 offset:41984
    v_mul_f32 v111, v111, v31
    v_exp_f32 v104, v104
    v_exp_f32 v105, v105
    v_mfma_f32_32x32x16_bf16 v[40:55], v[168:171], v[64:67], v[40:55]
    ds_read_b128 v[96:99], v1 offset:43008
    v_exp_f32 v106, v106
    v_exp_f32 v107, v107
    v_exp_f32 v108, v108
    v_mfma_f32_32x32x16_bf16 v[40:55], v[172:175], v[68:71], v[40:55]
    ds_read_b128 v[56:59], v1 offset:44032
    v_exp_f32 v109, v109
    v_exp_f32 v110, v110
    v_exp_f32 v111, v111
    s_waitcnt lgkmcnt(4)
    v_mfma_f32_32x32x16_bf16 v[40:55], v[176:179], v[72:75], v[40:55]
    ds_read_b128 v[60:63], v1 offset:45056
    v_fma_f32 v104, v104, v140, v140
    v_fma_f32 v105, v105, v140, v140
    v_fma_f32 v106, v106, v140, v140
    v_fma_f32 v107, v107, v140, v140
    v_fma_f32 v108, v108, v140, v140
    v_mfma_f32_32x32x16_bf16 v[40:55], v[180:183], v[76:79], v[40:55]
    ds_read_b128 v[64:67], v1 offset:46080
    v_fma_f32 v109, v109, v140, v140
    v_fma_f32 v110, v110, v140, v140
    v_fma_f32 v111, v111, v140, v140
    v_rcp_f32 v104, v104
    v_rcp_f32 v105, v105
    v_mfma_f32_32x32x16_bf16 v[40:55], v[184:187], v[80:83], v[40:55]
    ds_read_b128 v[68:71], v1 offset:47104
    ds_read_b64 v[120:121], v16 offset:28672
    ds_read_b64 v[122:123], v16 offset:29184
    v_rcp_f32 v106, v106
    v_mfma_f32_32x32x16_bf16 v[40:55], v[188:191], v[84:87], v[40:55]
    ds_read_b128 v[72:75], v1 offset:48128
    v_rcp_f32 v107, v107
    v_rcp_f32 v108, v108
    v_rcp_f32 v109, v109
    s_waitcnt lgkmcnt(6)
    v_mfma_f32_32x32x16_bf16 v[40:55], v[192:195], v[88:91], v[40:55]
    ds_read_b128 v[76:79], v1 offset:49152
    v_rcp_f32 v110, v110
    v_rcp_f32 v111, v111
    v_mul_f32 v104, v104, v24
    v_mfma_f32_32x32x16_bf16 v[40:55], v[196:199], v[92:95], v[40:55]
    ds_read_b128 v[80:83], v1 offset:50176
    v_mul_f32 v105, v105, v25
    v_mul_f32 v106, v106, v26
    v_mul_f32 v107, v107, v27
    v_mul_f32 v108, v108, v28
    v_mul_f32 v109, v109, v29
    v_mul_f32 v110, v110, v30
    v_mfma_f32_32x32x16_bf16 v[40:55], v[200:203], v[96:99], v[40:55]
    ds_read_b128 v[84:87], v1 offset:51200
    v_mul_f32 v111, v111, v31
    v_cvt_pk_bf16_f32 v100, v104, v105
    v_cvt_pk_bf16_f32 v101, v106, v107
    v_cvt_pk_bf16_f32 v102, v108, v109
    v_cvt_pk_bf16_f32 v103, v110, v111
    v_mul_f32 v104, v32, v32
    v_mfma_f32_32x32x16_bf16 v[40:55], v[204:207], v[56:59], v[40:55]
    ds_read_b128 v[88:91], v1 offset:52224
    v_mul_f32 v105, v33, v33
    v_mul_f32 v106, v34, v34
    v_mul_f32 v107, v35, v35
    v_mul_f32 v108, v36, v36
    v_mul_f32 v109, v37, v37
    v_mul_f32 v110, v38, v38
    s_waitcnt lgkmcnt(4)
    v_mfma_f32_32x32x16_bf16 v[40:55], v[208:211], v[60:63], v[40:55]
    ds_read_b128 v[92:95], v1 offset:53248
    v_mul_f32 v111, v39, v39
    v_fma_f32 v104, v104, v139, v138
    v_fma_f32 v105, v105, v139, v138
    v_fma_f32 v106, v106, v139, v138
    v_mfma_f32_32x32x16_bf16 v[40:55], v[212:215], v[64:67], v[40:55]
    ds_read_b128 v[96:99], v1 offset:54272
    v_fma_f32 v107, v107, v139, v138
    v_fma_f32 v108, v108, v139, v138
    v_fma_f32 v109, v109, v139, v138
    v_fma_f32 v110, v110, v139, v138
    v_fma_f32 v111, v111, v139, v138
    v_mul_f32 v104, v104, v32
    v_mfma_f32_32x32x16_bf16 v[40:55], v[216:219], v[68:71], v[40:55]
    ds_read_b128 v[56:59], v1 offset:55296
    v_mul_f32 v105, v105, v33
    v_mul_f32 v106, v106, v34
    v_mul_f32 v107, v107, v35
    v_mul_f32 v108, v108, v36
    v_mul_f32 v109, v109, v37
    v_mul_f32 v110, v110, v38
    v_mfma_f32_32x32x16_bf16 v[40:55], v[220:223], v[72:75], v[40:55]
    ds_read_b128 v[60:63], v1 offset:56320
    v_mul_f32 v111, v111, v39
    v_exp_f32 v104, v104
    v_exp_f32 v105, v105
    s_waitcnt lgkmcnt(4)
    v_mfma_f32_32x32x16_bf16 v[40:55], v[224:227], v[76:79], v[40:55]
    v_exp_f32 v106, v106
    v_exp_f32 v107, v107
    v_exp_f32 v108, v108
    v_mfma_f32_32x32x16_bf16 v[40:55], v[228:231], v[80:83], v[40:55]
    v_exp_f32 v109, v109
    v_exp_f32 v110, v110
    v_exp_f32 v111, v111
    v_add_u32 v17, 4, v3
    v_mfma_f32_32x32x16_bf16 v[40:55], v[232:235], v[84:87], v[40:55]
    s_waitcnt vmcnt(0)
    buffer_store_dword v17, v8, s[44:47], s9 offen offset:512
    v_fma_f32 v104, v104, v140, v140
    v_fma_f32 v105, v105, v140, v140
    v_fma_f32 v106, v106, v140, v140
    v_fma_f32 v107, v107, v140, v140
    v_fma_f32 v108, v108, v140, v140
    v_mfma_f32_32x32x16_bf16 v[40:55], v[236:239], v[88:91], v[40:55]
    v_fma_f32 v109, v109, v140, v140
    v_fma_f32 v110, v110, v140, v140
    v_fma_f32 v111, v111, v140, v140
    v_rcp_f32 v104, v104
    v_rcp_f32 v105, v105
    s_waitcnt lgkmcnt(0)
    v_mfma_f32_32x32x16_bf16 v[40:55], v[240:243], v[92:95], v[40:55]
    v_rcp_f32 v106, v106
    v_rcp_f32 v107, v107
    v_rcp_f32 v108, v108
    v_mfma_f32_32x32x16_bf16 v[40:55], v[244:247], v[96:99], v[40:55]
    v_rcp_f32 v109, v109
    v_rcp_f32 v110, v110
    v_rcp_f32 v111, v111
    v_mfma_f32_32x32x16_bf16 v[40:55], v[248:251], v[56:59], v[40:55]
    v_mul_f32 v104, v104, v32
    v_mul_f32 v105, v105, v33
    v_mul_f32 v106, v106, v34
    v_mul_f32 v107, v107, v35
    v_mul_f32 v108, v108, v36
    v_mul_f32 v109, v109, v37
    v_mul_f32 v110, v110, v38
    v_mfma_f32_32x32x16_bf16 v[40:55], v[252:255], v[60:63], v[40:55]
    v_mul_f32 v111, v111, v39
    v_cvt_pk_bf16_f32 v112, v104, v105
    v_cvt_pk_bf16_f32 v113, v106, v107
    v_cvt_pk_bf16_f32 v114, v108, v109
    v_cvt_pk_bf16_f32 v115, v110, v111
    buffer_store_dwordx4 v[100:103], v1, s[44:47], s16 offen sc1
    buffer_store_dwordx4 v[112:115], v11, s[44:47], s16 offen sc1
    s_setprio 0
    v_lshlrev_b32 v20, 1, v7
    v_xor_b32 v20, v20, v6
    v_lshlrev_b32 v20, 4, v20
    v_lshl_add_u32 v20, v6, 8, v20
    s_lshl_b32 s4, s48, 13
    s_add_u32 s4, s4, 62464
    v_add_u32 v12, s4, v20
    v_xor_b32 v16, 16, v12
    v_add_u32 v10, 57344, v12
    v_add_u32 v15, 57344, v16
    v_mul_u32_u24 v20, 896, v6
    v_lshl_add_u32 v14, v7, 4, v20
    v_mul_f32 v104, v40, v40
    v_mul_f32 v105, v41, v41
    v_mul_f32 v106, v42, v42
    v_mul_f32 v107, v43, v43
    v_mul_f32 v108, v44, v44
    v_mul_f32 v109, v45, v45
    v_mul_f32 v110, v46, v46
    v_mul_f32 v111, v47, v47
    v_fma_f32 v104, v104, v142, v141
    v_fma_f32 v105, v105, v142, v141
    v_fma_f32 v106, v106, v142, v141
    v_fma_f32 v107, v107, v142, v141
    v_fma_f32 v108, v108, v142, v141
    v_fma_f32 v109, v109, v142, v141
    v_fma_f32 v110, v110, v142, v141
    v_fma_f32 v111, v111, v142, v141
    v_mul_f32 v104, v104, v40
    v_mul_f32 v105, v105, v41
    v_mul_f32 v106, v106, v42
    v_mul_f32 v107, v107, v43
    v_mul_f32 v108, v108, v44
    v_mul_f32 v109, v109, v45
    v_mul_f32 v110, v110, v46
    v_mul_f32 v111, v111, v47
    v_exp_f32 v104, v104
    v_exp_f32 v105, v105
    v_exp_f32 v106, v106
    v_exp_f32 v107, v107
    v_exp_f32 v108, v108
    v_exp_f32 v109, v109
    v_exp_f32 v110, v110
    v_exp_f32 v111, v111
    v_fma_f32 v104, v104, v143, v143
    v_fma_f32 v105, v105, v143, v143
    v_fma_f32 v106, v106, v143, v143
    v_fma_f32 v107, v107, v143, v143
    v_fma_f32 v108, v108, v143, v143
    v_fma_f32 v109, v109, v143, v143
    v_fma_f32 v110, v110, v143, v143
    v_fma_f32 v111, v111, v143, v143
    v_rcp_f32 v104, v104
    v_rcp_f32 v105, v105
    v_rcp_f32 v106, v106
    v_rcp_f32 v107, v107
    v_rcp_f32 v108, v108
    v_rcp_f32 v109, v109
    v_rcp_f32 v110, v110
    v_rcp_f32 v111, v111
    v_mul_f32 v104, v104, v40
    v_mul_f32 v105, v105, v41
    v_mul_f32 v106, v106, v42
    v_mul_f32 v107, v107, v43
    v_mul_f32 v108, v108, v44
    v_mul_f32 v109, v109, v45
    v_mul_f32 v110, v110, v46
    v_mul_f32 v111, v111, v47
    v_cvt_pk_bf16_f32 v100, v104, v105
    v_cvt_pk_bf16_f32 v101, v106, v107
    v_cvt_pk_bf16_f32 v102, v108, v109
    v_cvt_pk_bf16_f32 v103, v110, v111
    v_mul_f32 v104, v48, v48
    v_mul_f32 v105, v49, v49
    v_mul_f32 v106, v50, v50
    v_mul_f32 v107, v51, v51
    v_mul_f32 v108, v52, v52
    v_mul_f32 v109, v53, v53
    v_mul_f32 v110, v54, v54
    v_mul_f32 v111, v55, v55
    v_fma_f32 v104, v104, v142, v141
    v_fma_f32 v105, v105, v142, v141
    v_fma_f32 v106, v106, v142, v141
    v_fma_f32 v107, v107, v142, v141
    v_fma_f32 v108, v108, v142, v141
    v_fma_f32 v109, v109, v142, v141
    v_fma_f32 v110, v110, v142, v141
    v_fma_f32 v111, v111, v142, v141
    v_mul_f32 v104, v104, v48
    v_mul_f32 v105, v105, v49
    v_mul_f32 v106, v106, v50
    v_mul_f32 v107, v107, v51
    v_mul_f32 v108, v108, v52
    v_mul_f32 v109, v109, v53
    v_mul_f32 v110, v110, v54
    v_mul_f32 v111, v111, v55
    v_exp_f32 v104, v104
    v_exp_f32 v105, v105
    v_exp_f32 v106, v106
    v_exp_f32 v107, v107
    v_exp_f32 v108, v108
    v_exp_f32 v109, v109
    v_exp_f32 v110, v110
    v_exp_f32 v111, v111
    v_add_u32 v17, 6, v3
    s_waitcnt vmcnt(0)
    buffer_store_dword v17, v8, s[44:47], s9 offen offset:512
    v_fma_f32 v104, v104, v143, v143
    v_fma_f32 v105, v105, v143, v143
    v_fma_f32 v106, v106, v143, v143
    v_fma_f32 v107, v107, v143, v143
    v_fma_f32 v108, v108, v143, v143
    v_fma_f32 v109, v109, v143, v143
    v_fma_f32 v110, v110, v143, v143
    v_fma_f32 v111, v111, v143, v143
    v_rcp_f32 v104, v104
    v_rcp_f32 v105, v105
    v_rcp_f32 v106, v106
    v_rcp_f32 v107, v107
    v_rcp_f32 v108, v108
    v_rcp_f32 v109, v109
    v_rcp_f32 v110, v110
    v_rcp_f32 v111, v111
    v_mul_f32 v104, v104, v48
    v_mul_f32 v105, v105, v49
    v_mul_f32 v106, v106, v50
    v_mul_f32 v107, v107, v51
    v_mul_f32 v108, v108, v52
    v_mul_f32 v109, v109, v53
    v_mul_f32 v110, v110, v54
    v_mul_f32 v111, v111, v55
    v_cvt_pk_bf16_f32 v112, v104, v105
    v_cvt_pk_bf16_f32 v113, v106, v107
    v_cvt_pk_bf16_f32 v114, v108, v109
    v_cvt_pk_bf16_f32 v115, v110, v111
    buffer_store_dwordx4 v[100:103], v1, s[44:47], s18 offen sc1
    buffer_store_dwordx4 v[112:115], v11, s[44:47], s18 offen sc1
    v_lshlrev_b32 v124, 16, v116
    v_and_b32 v125, 0xffff0000, v116
    v_lshlrev_b32 v126, 16, v117
    v_and_b32 v127, 0xffff0000, v117
    v_lshlrev_b32 v128, 16, v118
    v_and_b32 v129, 0xffff0000, v118
    v_lshlrev_b32 v130, 16, v119
    v_and_b32 v131, 0xffff0000, v119
    v_lshlrev_b32 v132, 16, v120
    v_and_b32 v133, 0xffff0000, v120
    v_lshlrev_b32 v134, 16, v121
    v_and_b32 v135, 0xffff0000, v121
    v_lshlrev_b32 v136, 16, v122
    v_and_b32 v137, 0xffff0000, v122
    v_lshlrev_b32 v138, 16, v123
    v_and_b32 v139, 0xffff0000, v123
    v_min_u32 v23, 27, v0
    v_lshlrev_b32 v23, 2, v23
    v_add_u32 v17, 8, v3
    s_waitcnt vmcnt(0)
    buffer_store_dword v17, v8, s[44:47], s9 offen offset:512
    s_barrier
    ds_read_b128 v[56:59], v10 offset:0
    ds_read_b128 v[60:63], v15 offset:0
    ds_read_b128 v[64:67], v10 offset:2048
    ds_read_b128 v[68:71], v15 offset:2048
    ds_read_b128 v[72:75], v10 offset:4096
    ds_read_b128 v[76:79], v15 offset:4096
    ds_read_b128 v[80:83], v10 offset:6144
    ds_read_b128 v[84:87], v15 offset:6144
    buffer_load_dword v22, v23, s[44:47], s54 offen offset:1920 sc1
    s_waitcnt lgkmcnt(5)
    v_add_f32 v56, v56, v64
    v_add_f32 v57, v57, v65
    v_add_f32 v58, v58, v66
    v_add_f32 v59, v59, v67
    s_waitcnt lgkmcnt(4)
    v_add_f32 v60, v60, v68
    v_add_f32 v61, v61, v69
    v_add_f32 v62, v62, v70
    v_add_f32 v63, v63, v71
    s_waitcnt lgkmcnt(3)
    v_add_f32 v56, v56, v72
    v_add_f32 v57, v57, v73
    v_add_f32 v58, v58, v74
    v_add_f32 v59, v59, v75
    s_waitcnt lgkmcnt(2)
    v_add_f32 v60, v60, v76
    v_add_f32 v61, v61, v77
    v_add_f32 v62, v62, v78
    v_add_f32 v63, v63, v79
    s_waitcnt lgkmcnt(1)
    v_add_f32 v56, v56, v80
    v_add_f32 v57, v57, v81
    v_add_f32 v58, v58, v82
    v_add_f32 v59, v59, v83
    s_waitcnt lgkmcnt(0)
    v_add_f32 v60, v60, v84
    v_add_f32 v61, v61, v85
    v_add_f32 v62, v62, v86
    v_add_f32 v63, v63, v87
    v_cvt_pk_bf16_f32 v96, v56, v57
    v_cvt_pk_bf16_f32 v97, v58, v59
    v_cvt_pk_bf16_f32 v98, v60, v61
    v_cvt_pk_bf16_f32 v99, v62, v63
    s_waitcnt vmcnt(0)
    v_cmp_ne_u32 vcc, s53, v22
    s_cbranch_vccnz Lslowpoll_10
Lback_11:
    buffer_store_dwordx4 v[96:99], v14, s[40:43], s17 offen
    s_add_u32 s17, s17, 28672
    s_barrier
    ds_read_b128 v[56:59], v12 offset:0
    ds_read_b128 v[60:63], v16 offset:0
    ds_read_b128 v[64:67], v12 offset:2048
    ds_read_b128 v[68:71], v16 offset:2048
    ds_read_b128 v[72:75], v12 offset:4096
    ds_read_b128 v[76:79], v16 offset:4096
    ds_read_b128 v[80:83], v12 offset:6144
    ds_read_b128 v[84:87], v16 offset:6144
    s_waitcnt lgkmcnt(5)
    v_add_f32 v56, v56, v64
    v_add_f32 v57, v57, v65
    v_add_f32 v58, v58, v66
    v_add_f32 v59, v59, v67
    s_waitcnt lgkmcnt(4)
    v_add_f32 v60, v60, v68
    v_add_f32 v61, v61, v69
    v_add_f32 v62, v62, v70
    v_add_f32 v63, v63, v71
    s_waitcnt lgkmcnt(3)
    v_add_f32 v56, v56, v72
    v_add_f32 v57, v57, v73
    v_add_f32 v58, v58, v74
    v_add_f32 v59, v59, v75
    s_waitcnt lgkmcnt(2)
    v_add_f32 v60, v60, v76
    v_add_f32 v61, v61, v77
    v_add_f32 v62, v62, v78
    v_add_f32 v63, v63, v79
    s_waitcnt lgkmcnt(1)
    v_add_f32 v56, v56, v80
    v_add_f32 v57, v57, v81
    v_add_f32 v58, v58, v82
    v_add_f32 v59, v59, v83
    s_waitcnt lgkmcnt(0)
    v_add_f32 v60, v60, v84
    v_add_f32 v61, v61, v85
    v_add_f32 v62, v62, v86
    v_add_f32 v63, v63, v87
    v_cvt_pk_bf16_f32 v100, v56, v57
    v_cvt_pk_bf16_f32 v101, v58, v59
    v_cvt_pk_bf16_f32 v102, v60, v61
    v_cvt_pk_bf16_f32 v103, v62, v63
    buffer_store_dwordx4 v[100:103], v14, s[40:43], s17 offen
    s_waitcnt vmcnt(0)
    buffer_store_dword v3, v8, s[44:47], s12 offen offset:1024
    s_barrier
    ds_read_b128 v[56:59], v10 offset:0
    ds_read_b128 v[60:63], v15 offset:0
    ds_read_b128 v[64:67], v10 offset:2048
    ds_read_b128 v[68:71], v15 offset:2048
    ds_read_b128 v[72:75], v10 offset:4096
    ds_read_b128 v[76:79], v15 offset:4096
    ds_read_b128 v[80:83], v10 offset:6144
    ds_read_b128 v[84:87], v15 offset:6144
    buffer_load_dword v22, v2, s[44:47], s13 offen offset:1024 sc1
    s_waitcnt lgkmcnt(7)
    v_add_f32 v56, v56, v124
    v_add_f32 v57, v57, v125
    v_add_f32 v58, v58, v126
    v_add_f32 v59, v59, v127
    s_waitcnt lgkmcnt(6)
    v_add_f32 v60, v60, v128
    v_add_f32 v61, v61, v129
    v_add_f32 v62, v62, v130
    v_add_f32 v63, v63, v131
    s_waitcnt lgkmcnt(5)
    v_add_f32 v56, v56, v64
    v_add_f32 v57, v57, v65
    v_add_f32 v58, v58, v66
    v_add_f32 v59, v59, v67
    s_waitcnt lgkmcnt(4)
    v_add_f32 v60, v60, v68
    v_add_f32 v61, v61, v69
    v_add_f32 v62, v62, v70
    v_add_f32 v63, v63, v71
    s_waitcnt lgkmcnt(3)
    v_add_f32 v56, v56, v72
    v_add_f32 v57, v57, v73
    v_add_f32 v58, v58, v74
    v_add_f32 v59, v59, v75
    s_waitcnt lgkmcnt(2)
    v_add_f32 v60, v60, v76
    v_add_f32 v61, v61, v77
    v_add_f32 v62, v62, v78
    v_add_f32 v63, v63, v79
    s_waitcnt lgkmcnt(1)
    v_add_f32 v24, v56, v80
    v_add_f32 v25, v57, v81
    v_add_f32 v26, v58, v82
    v_add_f32 v27, v59, v83
    s_waitcnt lgkmcnt(0)
    v_add_f32 v28, v60, v84
    v_add_f32 v29, v61, v85
    v_add_f32 v30, v62, v86
    v_add_f32 v31, v63, v87
    s_waitcnt vmcnt(0)
    v_cmp_ne_u32 vcc, s53, v22
    s_cbranch_vccnz Lslowpoll_12
Lback_13:
    s_add_u32 s4, s7, 28672
    buffer_load_dwordx4 v[88:91], v14, s[40:43], s7 offen sc1
    buffer_load_dwordx4 v[92:95], v14, s[40:43], s4 offen sc1
    s_waitcnt vmcnt(0)
    v_lshlrev_b32 v20, 16, v92
    v_and_b32 v21, 0xffff0000, v92
    v_add_f32 v132, v132, v20
    v_add_f32 v133, v133, v21
    v_lshlrev_b32 v20, 16, v93
    v_and_b32 v21, 0xffff0000, v93
    v_add_f32 v134, v134, v20
    v_add_f32 v135, v135, v21
    v_lshlrev_b32 v20, 16, v94
    v_and_b32 v21, 0xffff0000, v94
    v_add_f32 v136, v136, v20
    v_add_f32 v137, v137, v21
    v_lshlrev_b32 v20, 16, v95
    v_and_b32 v21, 0xffff0000, v95
    v_add_f32 v138, v138, v20
    v_add_f32 v139, v139, v21
    s_barrier
    ds_read_b128 v[56:59], v12 offset:0
    ds_read_b128 v[60:63], v16 offset:0
    ds_read_b128 v[64:67], v12 offset:2048
    ds_read_b128 v[68:71], v16 offset:2048
    ds_read_b128 v[72:75], v12 offset:4096
    ds_read_b128 v[76:79], v16 offset:4096
    ds_read_b128 v[80:83], v12 offset:6144
    ds_read_b128 v[84:87], v16 offset:6144
    v_lshlrev_b32 v20, 16, v88
    v_and_b32 v21, 0xffff0000, v88
    v_add_f32 v24, v24, v20
    v_add_f32 v25, v25, v21
    v_lshlrev_b32 v20, 16, v89
    v_and_b32 v21, 0xffff0000, v89
    v_add_f32 v26, v26, v20
    v_add_f32 v27, v27, v21
    v_lshlrev_b32 v20, 16, v90
    v_and_b32 v21, 0xffff0000, v90
    v_add_f32 v28, v28, v20
    v_add_f32 v29, v29, v21
    v_lshlrev_b32 v20, 16, v91
    v_and_b32 v21, 0xffff0000, v91
    v_add_f32 v30, v30, v20
    v_add_f32 v31, v31, v21
    v_cvt_pk_bf16_f32 v96, v24, v25
    v_cvt_pk_bf16_f32 v97, v26, v27
    v_cvt_pk_bf16_f32 v98, v28, v29
    v_cvt_pk_bf16_f32 v99, v30, v31
    buffer_store_dwordx4 v[96:99], v14, s[40:43], s7 offen
    s_add_u32 s7, s7, 28672
    s_waitcnt lgkmcnt(7)
    v_pk_add_f32 v[56:57], v[56:57], v[132:133]
    v_pk_add_f32 v[58:59], v[58:59], v[134:135]
    s_waitcnt lgkmcnt(6)
    v_pk_add_f32 v[60:61], v[60:61], v[136:137]
    v_pk_add_f32 v[62:63], v[62:63], v[138:139]
    s_waitcnt lgkmcnt(5)
    v_pk_add_f32 v[56:57], v[56:57], v[64:65]
    v_pk_add_f32 v[58:59], v[58:59], v[66:67]
    s_waitcnt lgkmcnt(4)
    v_pk_add_f32 v[60:61], v[60:61], v[68:69]
    v_pk_add_f32 v[62:63], v[62:63], v[70:71]
    s_waitcnt lgkmcnt(3)
    v_pk_add_f32 v[56:57], v[56:57], v[72:73]
    v_pk_add_f32 v[58:59], v[58:59], v[74:75]
    s_waitcnt lgkmcnt(2)
    v_pk_add_f32 v[60:61], v[60:61], v[76:77]
    v_pk_add_f32 v[62:63], v[62:63], v[78:79]
    s_waitcnt lgkmcnt(1)
    v_pk_add_f32 v[56:57], v[56:57], v[80:81]
    v_pk_add_f32 v[58:59], v[58:59], v[82:83]
    s_waitcnt lgkmcnt(0)
    v_pk_add_f32 v[60:61], v[60:61], v[84:85]
    v_pk_add_f32 v[62:63], v[62:63], v[86:87]
    v_cvt_pk_bf16_f32 v100, v56, v57
    v_cvt_pk_bf16_f32 v101, v58, v59
    v_cvt_pk_bf16_f32 v102, v60, v61
    v_cvt_pk_bf16_f32 v103, v62, v63
    buffer_store_dwordx4 v[100:103], v14, s[40:43], s7 offen
    s_endpgm
LB:
    s_lshl_b32 s58, s48, 10
    s_xor_b32 s51, s50, 1
    s_and_b32 s52, s50, 1
    s_lshl_b32 s54, s50, 19
    s_lshl_b32 s55, s51, 19
    s_mov_b32 s59, 0
    v_lshlrev_b32 v1, 4, v0
    v_mov_b32 v2, 0
    s_mov_b64 s[44:45], s[18:19]
    s_mov_b32 s46, 16777216
    s_mov_b32 s47, 0x20000
    s_mov_b64 s[24:25], s[6:7]
    s_mov_b32 s26, 401408
    s_mov_b32 s27, 0x20000
    s_mov_b64 s[28:29], s[8:9]
    s_mov_b32 s30, 401408
    s_mov_b32 s31, 0x20000
    s_mov_b64 s[32:33], s[10:11]
    s_mov_b32 s34, 1605632
    s_mov_b32 s35, 0x20000
    s_mov_b64 s[36:37], s[12:13]
    s_mov_b32 s38, 1605632
    s_mov_b32 s39, 0x20000
    s_mov_b64 s[40:41], s[14:15]
    s_mov_b32 s42, 1835008
    s_mov_b32 s43, 0x20000
    v_and_b32 v20, 2, v6
    s_and_b32 s3, s48, 1
    s_lshl_b32 s3, s3, 2
    v_or_b32 v20, s3, v20
    v_xor_b32 v20, v20, v7
    v_lshlrev_b32 v20, 4, v20
    v_add_u32 v14, v20, v21
    s_mul_i32 s3, s48, 56
    s_add_u32 s3, s3, s49
    s_lshl_b32 s3, s3, 7
    v_add_u32 v14, s3, v14
    v_add_u32 v11, s3, v11
    s_and_b32 s4, s54, s55
    s_add_u32 s4, s4, 384
    s_load_dword s53, s[44:45], s4
    v_and_b32 v4, 15, v0
    v_lshrrev_b32 v5, 4, v0
    v_mov_b32 v9, 163328
    v_min_u32 v8, 1, v0
    v_lshlrev_b32 v8, 31, v8
    v_lshrrev_b32 v20, 2, v0
    v_and_b32 v20, 3, v20
    v_xor_b32 v20, v20, v5
    v_lshlrev_b32 v20, 6, v20
    v_and_b32 v21, 3, v0
    v_lshl_add_u32 v20, v21, 4, v20
    v_mul_u32_u24 v21, 3584, v5
    v_add_u32 v10, v20, v21
    s_lshl_b32 s4, s48, 3
    s_add_u32 s4, s4, s52
    s_mul_i32 s4, s4, 7
    s_add_u32 s4, s4, s49
    s_lshl_b32 s4, s4, 8
    v_add_u32 v10, s4, v10
    s_lshl_b32 s4, s48, 4
    s_add_u32 s4, s4, 2
    v_add_u32 v20, s4, v4
    v_and_b32 v21, 6, v20
    v_lshrrev_b32 v22, 1, v5
    v_or_b32 v21, v21, v22
    v_lshlrev_b32 v21, 4, v21
    v_and_b32 v22, 1, v5
    v_lshl_add_u32 v21, v22, 3, v21
    v_lshl_add_u32 v21, v20, 7, v21
    v_mov_b32 v200, v21
    v_xor_b32 v201, 32, v200
    v_xor_b32 v202, 64, v200
    v_xor_b32 v203, 96, v200
    v_lshrrev_b32 v20, 2, v4
    v_and_b32 v21, 3, v4
    v_lshrrev_b32 v23, 1, v20
    v_and_b32 v22, 1, v5
    v_lshl_or_b32 v23, v22, 1, v23
    v_lshl_add_u32 v20, v22, 2, v20
    v_lshrrev_b32 v22, 1, v5
    v_lshl_add_u32 v20, v22, 4, v20
    v_lshlrev_b32 v20, 7, v20
    v_lshl_add_u32 v20, v21, 3, v20
    v_lshl_add_u32 v20, v23, 5, v20
    v_xor_b32 v15, 0, v20
    v_add_u32 v15, 119808, v15
    v_xor_b32 v16, 32, v20
    v_add_u32 v16, 119808, v16
    v_xor_b32 v17, 64, v20
    v_add_u32 v17, 119808, v17
    v_xor_b32 v18, 96, v20
    v_add_u32 v18, 119808, v18
    v_min_u32 v19, 27, v0
    v_lshlrev_b32 v19, 2, v19
    v_lshlrev_b32 v20, 9, v5
    v_lshl_add_u32 v249, v4, 4, v20
    v_lshrrev_b32 v20, 5, v0
    v_lshlrev_b32 v20, 2, v20
    v_lshl_add_u32 v250, v4, 3, v20
    v_min_u32 v248, 13, v0
    v_lshlrev_b32 v248, 2, v248
    s_lshl2_add_u32 s12, s50, s48
    s_mul_i32 s12, s12, 14336
    s_lshr_b32 s4, s48, 1
    s_mul_i32 s4, s4, 28672
    s_add_u32 s4, s4, s54
    s_add_u32 s4, s4, 4096
    s_and_b32 s5, s48, 1
    s_lshl_b32 s13, s49, 4
    s_add_u32 s13, s13, s5
    s_lshl_b32 s13, s13, 8
    s_add_u32 s13, s13, s4
    s_lshl_b32 s14, s49, 2
    s_add_u32 s14, s14, s48
    s_lshl_b32 s15, s14, 2
    s_lshl_b32 s14, s14, 7
    s_add_u32 s14, s14, s54
    s_add_u32 s14, s14, 61440
    s_add_u32 s15, s15, s54
    s_lshl_b32 s16, s48, 11
    s_add_u32 s16, s16, 119808
    s_mov_b32 s17, 0
    s_mov_b32 s18, 2048
    s_mov_b32 s19, 4096
    s_mov_b32 s8, 6144
    s_mov_b32 s3, 8192
    s_mov_b32 s57, 10240
    s_mov_b32 s9, 12288
    v_add_u32 v23, s12, v1
    s_setprio 2
    s_add_u32 m0, s67, 8704
    s_nop 0
    buffer_load_dwordx4 v12, s[20:23], s61 offen lds
    s_add_u32 m0, s67, 17408
    s_nop 0
    buffer_load_dwordx4 v12, s[20:23], s62 offen lds
    s_add_u32 m0, s67, 26112
    s_nop 0
    buffer_load_dwordx4 v12, s[20:23], s63 offen lds
    s_add_u32 m0, s67, 34816
    s_nop 0
    buffer_load_dwordx4 v12, s[20:23], s64 offen lds
    s_add_u32 m0, s67, 43520
    s_nop 0
    buffer_load_dwordx4 v12, s[20:23], s65 offen lds
    s_add_u32 m0, s67, 52224
    s_nop 0
    buffer_load_dwordx4 v12, s[20:23], s66 offen lds
    s_and_b32 s7, s54, s55
    v_lshrrev_b32 v20, 2, v0
    v_lshl_add_u32 v20, v20, 6, v1
    v_mov_b32 v22, 0x80000000
    v_cmp_gt_u32 vcc, 34, v0
    s_nop 1
    v_cndmask_b32 v13, v22, v20, vcc
    s_add_u32 m0, s58, 62464
    s_mul_i32 s10, s60, 448
    buffer_load_dwordx4 v14, s[24:27], s10 offen  lds
    s_add_u32 m0, s58, 66560
    s_add_u32 s10, s10, 28672
    buffer_load_dwordx4 v14, s[24:27], s10 offen  lds
    s_add_u32 m0, s58, 70656
    s_mul_i32 s10, s61, 448
    buffer_load_dwordx4 v14, s[24:27], s10 offen  lds
    s_add_u32 m0, s58, 74752
    s_add_u32 s10, s10, 28672
    buffer_load_dwordx4 v14, s[24:27], s10 offen  lds
    s_add_u32 m0, s58, 78848
    s_mul_i32 s10, s62, 448
    buffer_load_dwordx4 v14, s[24:27], s10 offen  lds
    s_add_u32 m0, s58, 82944
    s_add_u32 s10, s10, 28672
    buffer_load_dwordx4 v14, s[24:27], s10 offen  lds
    s_add_u32 m0, s58, 87040
    s_mul_i32 s10, s63, 448
    buffer_load_dwordx4 v14, s[24:27], s10 offen  lds
    s_add_u32 m0, s58, 91136
    s_add_u32 s10, s10, 28672
    buffer_load_dwordx4 v14, s[24:27], s10 offen  lds
    s_add_u32 m0, s58, 95232
    s_mul_i32 s10, s64, 448
    buffer_load_dwordx4 v14, s[24:27], s10 offen  lds
    s_add_u32 m0, s58, 99328
    s_add_u32 s10, s10, 28672
    buffer_load_dwordx4 v14, s[24:27], s10 offen  lds
    s_waitcnt vmcnt(7)
    s_barrier
    ds_read_b64 v[240:241], v200 offset:0
    ds_read_b64 v[242:243], v201 offset:0
    ds_read_b64 v[244:245], v202 offset:0
    ds_read_b64 v[246:247], v203 offset:0
    s_add_u32 m0, s58, 103424
    s_mul_i32 s10, s65, 448
    buffer_load_dwordx4 v14, s[24:27], s10 offen  lds
    s_add_u32 m0, s58, 107520
    s_add_u32 s10, s10, 28672
    buffer_load_dwordx4 v14, s[24:27], s10 offen  lds
    s_add_u32 m0, s58, 111616
    s_mul_i32 s10, s66, 448
    buffer_load_dwordx4 v14, s[24:27], s10 offen  lds
    s_add_u32 m0, s58, 115712
    s_add_u32 s10, s10, 28672
    buffer_load_dwordx4 v14, s[24:27], s10 offen  lds
    s_waitcnt vmcnt(7)
    s_barrier
    s_mov_b32 m0, 163328
    s_nop 0
    buffer_load_dword v248, s[44:47], s7 offen offset:256 sc1 lds
    s_mov_b32 m0, 58880
    s_nop 0
    buffer_load_dwordx4 v13, s[44:47], s54 offen offset:2048 sc1 lds
    s_add_u32 m0, s58, 119808
    s_mul_i32 s5, s17, 28
    buffer_load_dwordx4 v11, s[28:31], s5 offen  lds
    s_add_u32 m0, s58, 123904
    s_mul_i32 s5, s17, 28
    s_add_u32 s5, s5, 28672
    buffer_load_dwordx4 v11, s[28:31], s5 offen  lds
    s_add_u32 m0, s58, 128000
    s_mul_i32 s5, s18, 28
    buffer_load_dwordx4 v11, s[28:31], s5 offen  lds
    s_waitcnt vmcnt(8)
    s_barrier
    s_add_u32 m0, s58, 132096
    s_mul_i32 s5, s18, 28
    s_add_u32 s5, s5, 28672
    buffer_load_dwordx4 v11, s[28:31], s5 offen  lds
    s_add_u32 m0, s58, 136192
    s_mul_i32 s5, s19, 28
    buffer_load_dwordx4 v11, s[28:31], s5 offen  lds
    s_add_u32 m0, s58, 140288
    s_mul_i32 s5, s19, 28
    s_add_u32 s5, s5, 28672
    buffer_load_dwordx4 v11, s[28:31], s5 offen  lds
    s_waitcnt vmcnt(8)
    s_barrier
    s_waitcnt lgkmcnt(0)
    s_add_u32 s53, s53, 0x9e3779b9
    s_and_b32 s53, s53, 0xffffffe0
    s_or_b32 s53, s53, 16
    v_mov_b32 v3, s53
    s_getreg_b32 s6, hwreg(HW_REG_XCC_ID, 0, 4)
    s_or_b32 s6, s6, s53
    s_add_u32 m0, s58, 144384
    s_mul_i32 s5, s8, 28
    buffer_load_dwordx4 v11, s[28:31], s5 offen  lds
    s_add_u32 m0, s58, 148480
    s_mul_i32 s5, s8, 28
    s_add_u32 s5, s5, 28672
    buffer_load_dwordx4 v11, s[28:31], s5 offen  lds
    s_add_u32 m0, s58, 152576
    s_mul_i32 s5, s3, 28
    buffer_load_dwordx4 v11, s[28:31], s5 offen  lds
    s_add_u32 m0, s58, 156672
    s_mul_i32 s5, s3, 28
    s_add_u32 s5, s5, 28672
    buffer_load_dwordx4 v11, s[28:31], s5 offen  lds
    s_barrier
    s_add_u32 m0, s58, 62464
    s_mul_i32 s5, s57, 28
    buffer_load_dwordx4 v11, s[28:31], s5 offen  lds
    s_add_u32 m0, s58, 66560
    s_mul_i32 s5, s57, 28
    s_add_u32 s5, s5, 28672
    buffer_load_dwordx4 v11, s[28:31], s5 offen  lds
    s_add_u32 m0, s58, 70656
    s_mul_i32 s5, s9, 28
    buffer_load_dwordx4 v11, s[28:31], s5 offen  lds
    s_add_u32 m0, s58, 74752
    s_mul_i32 s5, s9, 28
    s_add_u32 s5, s5, 28672
    buffer_load_dwordx4 v11, s[28:31], s5 offen  lds
    s_add_u32 m0, s58, 78848
    s_mov_b32 s5, 0
    buffer_load_dwordx4 v10, s[32:35], s5 offen  lds
    s_add_u32 m0, s58, 82944
    s_mov_b32 s5, 57344
    buffer_load_dwordx4 v10, s[32:35], s5 offen  lds
    s_add_u32 m0, s58, 87040
    s_mov_b32 s5, 114688
    buffer_load_dwordx4 v10, s[32:35], s5 offen  lds
    s_add_u32 m0, s58, 91136
    s_mov_b32 s5, 172032
    buffer_load_dwordx4 v10, s[32:35], s5 offen  lds
    s_add_u32 m0, s58, 95232
    s_mov_b32 s5, 229376
    buffer_load_dwordx4 v10, s[32:35], s5 offen  lds
    s_add_u32 m0, s58, 99328
    s_mov_b32 s5, 286720
    buffer_load_dwordx4 v10, s[32:35], s5 offen  lds
    s_waitcnt vmcnt(10)
    s_barrier
    v_add_u32 v20, 163584, v248
    ds_read_b32 v251, v20
    s_add_u32 m0, s58, 103424
    s_mov_b32 s5, 344064
    buffer_load_dwordx4 v10, s[32:35], s5 offen  lds
    s_add_u32 m0, s58, 107520
    s_mov_b32 s5, 401408
    buffer_load_dwordx4 v10, s[32:35], s5 offen  lds
    ds_read_b64_tr_b16 v[40:41], v15 offset:0
    ds_read_b64_tr_b16 v[42:43], v15 offset:1024
    ds_read_b64_tr_b16 v[44:45], v16 offset:0
    ds_read_b64_tr_b16 v[46:47], v16 offset:1024
    ds_read_b64_tr_b16 v[48:49], v17 offset:0
    ds_read_b64_tr_b16 v[50:51], v17 offset:1024
    ds_read_b64_tr_b16 v[52:53], v18 offset:0
    ds_read_b64_tr_b16 v[54:55], v18 offset:1024
    s_add_u32 m0, s58, 111616
    s_mov_b32 s5, 458752
    buffer_load_dwordx4 v10, s[32:35], s5 offen  lds
    s_add_u32 m0, s58, 115712
    s_mov_b32 s5, 516096
    buffer_load_dwordx4 v10, s[32:35], s5 offen  lds
    ds_read_b64_tr_b16 v[56:57], v15 offset:4096
    ds_read_b64_tr_b16 v[58:59], v15 offset:5120
    ds_read_b64_tr_b16 v[60:61], v16 offset:4096
    ds_read_b64_tr_b16 v[62:63], v16 offset:5120
    ds_read_b64_tr_b16 v[64:65], v17 offset:4096
    ds_read_b64_tr_b16 v[66:67], v17 offset:5120
    ds_read_b64_tr_b16 v[68:69], v18 offset:4096
    ds_read_b64_tr_b16 v[70:71], v18 offset:5120
    s_add_u32 m0, s58, 0
    s_mov_b32 s5, 573440
    buffer_load_dwordx4 v10, s[32:35], s5 offen  lds
    s_add_u32 m0, s58, 4096
    s_mov_b32 s5, 630784
    buffer_load_dwordx4 v10, s[32:35], s5 offen  lds
    ds_read_b64_tr_b16 v[72:73], v15 offset:8192
    ds_read_b64_tr_b16 v[74:75], v15 offset:9216
    ds_read_b64_tr_b16 v[76:77], v16 offset:8192
    ds_read_b64_tr_b16 v[78:79], v16 offset:9216
    ds_read_b64_tr_b16 v[80:81], v17 offset:8192
    ds_read_b64_tr_b16 v[82:83], v17 offset:9216
    ds_read_b64_tr_b16 v[84:85], v18 offset:8192
    ds_read_b64_tr_b16 v[86:87], v18 offset:9216
    ds_read_b64_tr_b16 v[88:89], v15 offset:12288
    ds_read_b64_tr_b16 v[90:91], v15 offset:13312
    ds_read_b64_tr_b16 v[92:93], v16 offset:12288
    ds_read_b64_tr_b16 v[94:95], v16 offset:13312
    ds_read_b64_tr_b16 v[96:97], v17 offset:12288
    ds_read_b64_tr_b16 v[98:99], v17 offset:13312
    ds_read_b64_tr_b16 v[100:101], v18 offset:12288
    ds_read_b64_tr_b16 v[102:103], v18 offset:13312
    ds_read_b64_tr_b16 v[104:105], v15 offset:16384
    ds_read_b64_tr_b16 v[106:107], v15 offset:17408
    ds_read_b64_tr_b16 v[108:109], v16 offset:16384
    ds_read_b64_tr_b16 v[110:111], v16 offset:17408
    ds_read_b64_tr_b16 v[112:113], v17 offset:16384
    ds_read_b64_tr_b16 v[114:115], v17 offset:17408
    ds_read_b64_tr_b16 v[116:117], v18 offset:16384
    ds_read_b64_tr_b16 v[118:119], v18 offset:17408
    ds_read_b64_tr_b16 v[120:121], v15 offset:20480
    ds_read_b64_tr_b16 v[122:123], v15 offset:21504
    ds_read_b64_tr_b16 v[124:125], v16 offset:20480
    ds_read_b64_tr_b16 v[126:127], v16 offset:21504
    ds_read_b64_tr_b16 v[128:129], v17 offset:20480
    ds_read_b64_tr_b16 v[130:131], v17 offset:21504
    ds_read_b64_tr_b16 v[132:133], v18 offset:20480
    ds_read_b64_tr_b16 v[134:135], v18 offset:21504
    ds_read_b64_tr_b16 v[136:137], v15 offset:24576
    ds_read_b64_tr_b16 v[138:139], v15 offset:25600
    ds_read_b64_tr_b16 v[140:141], v16 offset:24576
    ds_read_b64_tr_b16 v[142:143], v16 offset:25600
    ds_read_b64_tr_b16 v[144:145], v17 offset:24576
    ds_read_b64_tr_b16 v[146:147], v17 offset:25600
    ds_read_b64_tr_b16 v[148:149], v18 offset:24576
    ds_read_b64_tr_b16 v[150:151], v18 offset:25600
    ds_read_b64_tr_b16 v[152:153], v15 offset:28672
    ds_read_b64_tr_b16 v[154:155], v15 offset:29696
    ds_read_b64_tr_b16 v[156:157], v16 offset:28672
    ds_read_b64_tr_b16 v[158:159], v16 offset:29696
    ds_read_b64_tr_b16 v[160:161], v17 offset:28672
    ds_read_b64_tr_b16 v[162:163], v17 offset:29696
    ds_read_b64_tr_b16 v[164:165], v18 offset:28672
    ds_read_b64_tr_b16 v[166:167], v18 offset:29696
    ds_read_b64_tr_b16 v[168:169], v15 offset:32768
    ds_read_b64_tr_b16 v[170:171], v15 offset:33792
    ds_read_b64_tr_b16 v[172:173], v16 offset:32768
    ds_read_b64_tr_b16 v[174:175], v16 offset:33792
    ds_read_b64_tr_b16 v[176:177], v17 offset:32768
    ds_read_b64_tr_b16 v[178:179], v17 offset:33792
    ds_read_b64_tr_b16 v[180:181], v18 offset:32768
    ds_read_b64_tr_b16 v[182:183], v18 offset:33792
    ds_read_b64_tr_b16 v[184:185], v15 offset:36864
    ds_read_b64_tr_b16 v[186:187], v15 offset:37888
    ds_read_b64_tr_b16 v[188:189], v16 offset:36864
    ds_read_b64_tr_b16 v[190:191], v16 offset:37888
    ds_read_b64_tr_b16 v[192:193], v17 offset:36864
    ds_read_b64_tr_b16 v[194:195], v17 offset:37888
    ds_read_b64_tr_b16 v[196:197], v18 offset:36864
    ds_read_b64_tr_b16 v[198:199], v18 offset:37888
    v_lshlrev_b32 v24, 16, v240
    v_and_b32 v25, 0xffff0000, v240
    v_lshlrev_b32 v26, 16, v241
    v_and_b32 v27, 0xffff0000, v241
    v_lshlrev_b32 v28, 16, v242
    v_and_b32 v29, 0xffff0000, v242
    v_lshlrev_b32 v30, 16, v243
    v_and_b32 v31, 0xffff0000, v243
    v_lshlrev_b32 v32, 16, v244
    v_and_b32 v33, 0xffff0000, v244
    v_lshlrev_b32 v34, 16, v245
    v_and_b32 v35, 0xffff0000, v245
    v_lshlrev_b32 v36, 16, v246
    v_and_b32 v37, 0xffff0000, v246
    v_lshlrev_b32 v38, 16, v247
    v_and_b32 v39, 0xffff0000, v247
    v_add_u32 v252, -57344, v15
    v_add_u32 v253, -57344, v16
    v_add_u32 v254, -57344, v17
    v_add_u32 v255, -57344, v18
    s_waitcnt lgkmcnt(14)
    v_cmp_ne_u32 vcc, s6, v251
    s_cbranch_vccnz LB_retry
LB_fast:
    v_mov_b32 v248, 0x3f803f80
    s_waitcnt vmcnt(0)
    s_waitcnt lgkmcnt(0)
    s_barrier
Lpoll_14:
    buffer_load_dword v20, v19, s[44:47], s54 offen offset:0 sc1
    s_add_u32 s59, s59, 1
    s_cmp_gt_u32 s59, 0x100000
    s_cbranch_scc1 Lend
    s_waitcnt vmcnt(0)
    v_cmp_ne_u32 vcc, s53, v20
    s_cbranch_vccnz Lpoll_14
    buffer_load_dwordx4 v[200:203], v23, s[40:43], s17 offen offset:0 sc1
    v_and_b32 v20, 31, v0
    v_min_u32 v20, 27, v20
    v_lshrrev_b32 v21, 5, v0
    v_lshlrev_b32 v21, 19, v21
    v_lshl_add_u32 v19, v20, 2, v21
    v_and_b32 v20, 2, v6
    v_lshlrev_b32 v20, 1, v20
    v_xor_b32 v20, v20, v7
    buffer_load_dwordx4 v[204:207], v23, s[40:43], s17 offen offset:1024 sc1
    v_lshlrev_b32 v20, 4, v20
    v_mul_u32_u24 v21, 896, v6
    v_add_u32 v20, v20, v21
    s_mul_i32 s4, s52, 28
    s_add_u32 s4, s4, s48
    s_mul_i32 s4, s4, 224
    s_add_u32 s4, s4, s49
    s_lshl_b32 s4, s4, 7
    buffer_load_dwordx4 v[208:211], v23, s[40:43], s18 offen offset:0 sc1
    v_add_u32 v11, s4, v20
    v_add_u32 v12, 6144, v11
    v_lshrrev_b32 v20, 2, v4
    v_and_b32 v21, 3, v4
    v_lshrrev_b32 v22, 1, v20
    v_lshlrev_b32 v22, 6, v22
    v_lshl_add_u32 v22, v21, 3, v22
    v_and_b32 v244, 1, v5
    buffer_load_dwordx4 v[212:215], v23, s[40:43], s18 offen offset:1024 sc1
    v_lshl_add_u32 v22, v244, 5, v22
    v_lshrrev_b32 v244, 1, v5
    v_lshl_add_u32 v244, v244, 2, v20
    v_lshl_add_u32 v22, v244, 7, v22
    v_add_u32 v13, s16, v22
    v_xor_b32 v14, 64, v13
    v_lshrrev_b32 v21, 5, v0
    v_xor_b32 v21, v21, v7
    buffer_load_dwordx4 v[216:219], v23, s[40:43], s19 offen offset:0 sc1
    v_lshlrev_b32 v21, 4, v21
    v_lshl_add_u32 v21, v7, 8, v21
    v_and_b32 v20, 3, v6
    v_lshl_add_u32 v20, v20, 13, v21
    v_add_u32 v240, s16, v20
    v_xor_b32 v241, 32, v240
    v_xor_b32 v242, 64, v240
    v_xor_b32 v243, 96, v240
    buffer_load_dwordx4 v[220:223], v23, s[40:43], s19 offen offset:1024 sc1
    v_min_u32 v9, 6, v0
    v_lshlrev_b32 v9, 2, v9
    s_add_u32 s4, s54, 4096
    s_add_u32 s4, s4, s58
    v_add_u32 v7, s4, v1
    s_add_u32 s4, s55, 4096
    s_add_u32 s4, s4, s58
    v_add_u32 v21, s4, v1
    buffer_load_dwordx4 v[224:227], v23, s[40:43], s8 offen offset:0 sc1
    s_lshl_b32 s10, s48, 7
    s_add_u32 s10, s10, s54
    s_mul_i32 s56, s48, 14336
    s_add_u32 s56, s56, s54
    s_add_u32 s12, s54, s58
    s_add_u32 s50, s55, s58
    s_lshl_b32 s51, s48, 2
    v_mov_b32 v22, v23
    buffer_load_dwordx4 v[228:231], v23, s[40:43], s8 offen offset:1024 sc1
    s_add_u32 s4, s56, 122880
    v_add_u32 v4, s4, v1
    s_add_u32 s4, s56, 180224
    v_add_u32 v5, s4, v1
    s_add_u32 s4, s56, 237568
    v_add_u32 v6, s4, v1
    s_waitcnt vmcnt(7)
    v_mfma_f32_16x16x32_bf16 v[24:27], v[40:43], v[200:203], v[24:27]
    buffer_load_dwordx4 v[232:235], v23, s[40:43], s3 offen offset:0 sc1
    v_mfma_f32_16x16x32_bf16 v[28:31], v[44:47], v[200:203], v[28:31]
    v_mfma_f32_16x16x32_bf16 v[32:35], v[48:51], v[200:203], v[32:35]
    v_mfma_f32_16x16x32_bf16 v[36:39], v[52:55], v[200:203], v[36:39]
    s_waitcnt vmcnt(7)
    v_mfma_f32_16x16x32_bf16 v[24:27], v[56:59], v[204:207], v[24:27]
    buffer_load_dwordx4 v[236:239], v23, s[40:43], s3 offen offset:1024 sc1
    ds_read_b64_tr_b16 v[40:41], v252 offset:0
    ds_read_b64_tr_b16 v[42:43], v252 offset:1024
    ds_read_b64_tr_b16 v[44:45], v253 offset:0
    ds_read_b64_tr_b16 v[46:47], v253 offset:1024
    ds_read_b64_tr_b16 v[48:49], v254 offset:0
    v_mfma_f32_16x16x32_bf16 v[28:31], v[60:63], v[204:207], v[28:31]
    ds_read_b64_tr_b16 v[50:51], v254 offset:1024
    v_mfma_f32_16x16x32_bf16 v[32:35], v[64:67], v[204:207], v[32:35]
    ds_read_b64_tr_b16 v[52:53], v255 offset:0
    v_mfma_f32_16x16x32_bf16 v[36:39], v[68:71], v[204:207], v[36:39]
    ds_read_b64_tr_b16 v[54:55], v255 offset:1024
    s_waitcnt vmcnt(7)
    v_mfma_f32_16x16x32_bf16 v[24:27], v[72:75], v[208:211], v[24:27]
    buffer_load_dwordx4 v[200:203], v23, s[40:43], s57 offen offset:0 sc1
    v_mfma_f32_16x16x32_bf16 v[28:31], v[76:79], v[208:211], v[28:31]
    ds_read_b64_tr_b16 v[56:57], v252 offset:4096
    v_mfma_f32_16x16x32_bf16 v[32:35], v[80:83], v[208:211], v[32:35]
    ds_read_b64_tr_b16 v[58:59], v252 offset:5120
    v_mfma_f32_16x16x32_bf16 v[36:39], v[84:87], v[208:211], v[36:39]
    ds_read_b64_tr_b16 v[60:61], v253 offset:4096
    s_waitcnt vmcnt(7)
    v_mfma_f32_16x16x32_bf16 v[24:27], v[88:91], v[212:215], v[24:27]
    buffer_load_dwordx4 v[204:207], v23, s[40:43], s57 offen offset:1024 sc1
    ds_read_b64_tr_b16 v[62:63], v253 offset:5120
    v_mfma_f32_16x16x32_bf16 v[28:31], v[92:95], v[212:215], v[28:31]
    ds_read_b64_tr_b16 v[64:65], v254 offset:4096
    v_mfma_f32_16x16x32_bf16 v[32:35], v[96:99], v[212:215], v[32:35]
    ds_read_b64_tr_b16 v[66:67], v254 offset:5120
    v_mfma_f32_16x16x32_bf16 v[36:39], v[100:103], v[212:215], v[36:39]
    ds_read_b64_tr_b16 v[68:69], v255 offset:4096
    s_waitcnt vmcnt(7)
    v_mfma_f32_16x16x32_bf16 v[24:27], v[104:107], v[216:219], v[24:27]
    buffer_load_dwordx4 v[208:211], v23, s[40:43], s9 offen offset:0 sc1
    ds_read_b64_tr_b16 v[70:71], v255 offset:5120
    v_mfma_f32_16x16x32_bf16 v[28:31], v[108:111], v[216:219], v[28:31]
    v_mfma_f32_16x16x32_bf16 v[32:35], v[112:115], v[216:219], v[32:35]
    ds_read_b64_tr_b16 v[72:73], v252 offset:8192
    v_mfma_f32_16x16x32_bf16 v[36:39], v[116:119], v[216:219], v[36:39]
    ds_read_b64_tr_b16 v[74:75], v252 offset:9216
    s_waitcnt vmcnt(7)
    v_mfma_f32_16x16x32_bf16 v[24:27], v[120:123], v[220:223], v[24:27]
    buffer_load_dwordx4 v[212:215], v23, s[40:43], s9 offen offset:1024 sc1
    ds_read_b64_tr_b16 v[76:77], v253 offset:8192
    v_mfma_f32_16x16x32_bf16 v[28:31], v[124:127], v[220:223], v[28:31]
    ds_read_b64_tr_b16 v[78:79], v253 offset:9216
    v_mfma_f32_16x16x32_bf16 v[32:35], v[128:131], v[220:223], v[32:35]
    ds_read_b64_tr_b16 v[80:81], v254 offset:8192
    v_mfma_f32_16x16x32_bf16 v[36:39], v[132:135], v[220:223], v[36:39]
    ds_read_b64_tr_b16 v[82:83], v254 offset:9216
    s_waitcnt vmcnt(7)
    v_mfma_f32_16x16x32_bf16 v[24:27], v[136:139], v[224:227], v[24:27]
    ds_read_b64_tr_b16 v[84:85], v255 offset:8192
    s_add_u32 m0, s58, 8192
    v_mfma_f32_16x16x32_bf16 v[28:31], v[140:143], v[224:227], v[28:31]
    ds_read_b64_tr_b16 v[86:87], v255 offset:9216
    s_mov_b32 s5, 688128
    v_mfma_f32_16x16x32_bf16 v[32:35], v[144:147], v[224:227], v[32:35]
    buffer_load_dwordx4 v10, s[32:35], s5 offen  lds
    v_mfma_f32_16x16x32_bf16 v[36:39], v[148:151], v[224:227], v[36:39]
    ds_read_b64_tr_b16 v[88:89], v252 offset:12288
    s_waitcnt vmcnt(7)
    v_mfma_f32_16x16x32_bf16 v[24:27], v[152:155], v[228:231], v[24:27]
    ds_read_b64_tr_b16 v[90:91], v252 offset:13312
    s_add_u32 m0, s58, 12288
    v_mfma_f32_16x16x32_bf16 v[28:31], v[156:159], v[228:231], v[28:31]
    ds_read_b64_tr_b16 v[92:93], v253 offset:12288
    s_mov_b32 s5, 745472
    v_mfma_f32_16x16x32_bf16 v[32:35], v[160:163], v[228:231], v[32:35]
    ds_read_b64_tr_b16 v[94:95], v253 offset:13312
    buffer_load_dwordx4 v10, s[32:35], s5 offen  lds
    v_mfma_f32_16x16x32_bf16 v[36:39], v[164:167], v[228:231], v[36:39]
    ds_read_b64_tr_b16 v[96:97], v254 offset:12288
    s_waitcnt vmcnt(7)
    v_mfma_f32_16x16x32_bf16 v[24:27], v[168:171], v[232:235], v[24:27]
    ds_read_b64_tr_b16 v[98:99], v254 offset:13312
    s_add_u32 m0, s58, 16384
    v_mfma_f32_16x16x32_bf16 v[28:31], v[172:175], v[232:235], v[28:31]
    ds_read_b64_tr_b16 v[100:101], v255 offset:12288
    s_mov_b32 s5, 802816
    v_mfma_f32_16x16x32_bf16 v[32:35], v[176:179], v[232:235], v[32:35]
    ds_read_b64_tr_b16 v[102:103], v255 offset:13312
    buffer_load_dwordx4 v10, s[32:35], s5 offen  lds
    v_mfma_f32_16x16x32_bf16 v[36:39], v[180:183], v[232:235], v[36:39]
    s_waitcnt vmcnt(7)
    v_mfma_f32_16x16x32_bf16 v[24:27], v[184:187], v[236:239], v[24:27]
    s_add_u32 m0, s58, 20480
    v_mfma_f32_16x16x32_bf16 v[28:31], v[188:191], v[236:239], v[28:31]
    s_mov_b32 s5, 860160
    v_mfma_f32_16x16x32_bf16 v[32:35], v[192:195], v[236:239], v[32:35]
    buffer_load_dwordx4 v10, s[32:35], s5 offen  lds
    v_mfma_f32_16x16x32_bf16 v[36:39], v[196:199], v[236:239], v[36:39]
    s_waitcnt lgkmcnt(14)
    s_waitcnt vmcnt(7)
    v_mfma_f32_16x16x32_bf16 v[24:27], v[40:43], v[200:203], v[24:27]
    s_add_u32 m0, s58, 24576
    v_mfma_f32_16x16x32_bf16 v[28:31], v[44:47], v[200:203], v[28:31]
    s_mov_b32 s5, 917504
    v_mfma_f32_16x16x32_bf16 v[32:35], v[48:51], v[200:203], v[32:35]
    buffer_load_dwordx4 v10, s[32:35], s5 offen  lds
    v_mfma_f32_16x16x32_bf16 v[36:39], v[52:55], v[200:203], v[36:39]
    s_waitcnt vmcnt(7)
    v_mfma_f32_16x16x32_bf16 v[24:27], v[56:59], v[204:207], v[24:27]
    s_add_u32 m0, s58, 28672
    v_mfma_f32_16x16x32_bf16 v[28:31], v[60:63], v[204:207], v[28:31]
    s_mov_b32 s5, 974848
    v_mfma_f32_16x16x32_bf16 v[32:35], v[64:67], v[204:207], v[32:35]
    buffer_load_dwordx4 v10, s[32:35], s5 offen  lds
    v_mfma_f32_16x16x32_bf16 v[36:39], v[68:71], v[204:207], v[36:39]
    s_waitcnt lgkmcnt(8)
    s_waitcnt vmcnt(7)
    v_mfma_f32_16x16x32_bf16 v[24:27], v[72:75], v[208:211], v[24:27]
    s_add_u32 m0, s58, 32768
    v_mfma_f32_16x16x32_bf16 v[28:31], v[76:79], v[208:211], v[28:31]
    s_mov_b32 s5, 1032192
    v_mfma_f32_16x16x32_bf16 v[32:35], v[80:83], v[208:211], v[32:35]
    buffer_load_dwordx4 v10, s[32:35], s5 offen  lds
    v_mfma_f32_16x16x32_bf16 v[36:39], v[84:87], v[208:211], v[36:39]
    s_waitcnt lgkmcnt(0)
    s_waitcnt vmcnt(7)
    v_mfma_f32_16x16x32_bf16 v[24:27], v[88:91], v[212:215], v[24:27]
    s_add_u32 m0, s58, 36864
    v_mfma_f32_16x16x32_bf16 v[28:31], v[92:95], v[212:215], v[28:31]
    s_mov_b32 s5, 1089536
    v_mfma_f32_16x16x32_bf16 v[32:35], v[96:99], v[212:215], v[32:35]
    buffer_load_dwordx4 v10, s[32:35], s5 offen  lds
    v_mfma_f32_16x16x32_bf16 v[36:39], v[100:103], v[212:215], v[36:39]
    s_nop 1
    v_cvt_pk_bf16_f32 v40, v24, v25
    v_cvt_pk_bf16_f32 v41, v26, v27
    v_cvt_pk_bf16_f32 v42, v28, v29
    v_cvt_pk_bf16_f32 v43, v30, v31
    v_cvt_pk_bf16_f32 v44, v32, v33
    v_cvt_pk_bf16_f32 v45, v34, v35
    v_cvt_pk_bf16_f32 v46, v36, v37
    v_cvt_pk_bf16_f32 v47, v38, v39
    buffer_store_dwordx4 v[40:43], v249, s[44:47], s13 offen offset:0
    buffer_store_dwordx4 v[44:47], v249, s[44:47], s13 offen offset:2048
    v_dot2_f32_bf16 v48, v40, v248, 0
    v_dot2_f32_bf16 v49, v40, v40, 0
    v_dot2_f32_bf16 v50, v41, v248, 0
    v_dot2_f32_bf16 v51, v41, v41, 0
    v_dot2_f32_bf16 v48, v42, v248, v48
    v_dot2_f32_bf16 v49, v42, v42, v49
    v_dot2_f32_bf16 v50, v43, v248, v50
    v_dot2_f32_bf16 v51, v43, v43, v51
    v_dot2_f32_bf16 v48, v44, v248, v48
    v_dot2_f32_bf16 v49, v44, v44, v49
    v_dot2_f32_bf16 v50, v45, v248, v50
    v_dot2_f32_bf16 v51, v45, v45, v51
    v_dot2_f32_bf16 v48, v46, v248, v48
    v_dot2_f32_bf16 v49, v46, v46, v49
    v_dot2_f32_bf16 v50, v47, v248, v50
    v_dot2_f32_bf16 v51, v47, v47, v51
    s_nop 1
    v_add_f32 v48, v48, v50
    v_add_f32 v49, v49, v51
    s_nop 1
    v_permlane32_swap_b32 v48, v49
    v_add_f32 v48, v48, v49
    v_mov_b32 v49, v48
    s_nop 1
    v_permlane16_swap_b32 v48, v49
    v_add_f32 v48, v48, v49
    buffer_store_dword v48, v250, s[44:47], s14 offen
    s_add_u32 m0, s58, 40960
    s_mov_b32 s5, 1146880
    buffer_load_dwordx4 v10, s[32:35], s5 offen  lds
    s_add_u32 m0, s58, 45056
    s_mov_b32 s5, 1204224
    buffer_load_dwordx4 v10, s[32:35], s5 offen  lds
    s_add_u32 m0, s58, 49152
    s_mov_b32 s5, 1261568
    buffer_load_dwordx4 v10, s[32:35], s5 offen  lds
    s_add_u32 m0, s58, 53248
    s_mov_b32 s5, 1318912
    buffer_load_dwordx4 v10, s[32:35], s5 offen  lds
    s_add_u32 m0, s58, 119808
    s_mov_b32 s5, 1376256
    buffer_load_dwordx4 v10, s[32:35], s5 offen  lds
    s_add_u32 m0, s58, 123904
    s_mov_b32 s5, 1433600
    buffer_load_dwordx4 v10, s[32:35], s5 offen  lds
    s_add_u32 m0, s58, 128000
    s_mov_b32 s5, 1490944
    buffer_load_dwordx4 v10, s[32:35], s5 offen  lds
    s_add_u32 m0, s58, 132096
    s_mov_b32 s5, 1548288
    buffer_load_dwordx4 v10, s[32:35], s5 offen  lds
    v_mov_b32 v16, v240
    v_mov_b32 v17, v241
    v_mov_b32 v18, v242
    v_mov_b32 v23, v243
    s_mov_b32 s60, 0
    s_mov_b32 s61, 1024
    s_mov_b32 s62, 2048
    s_mov_b32 s63, 3072
    s_mov_b32 s64, 4096
    s_mov_b32 s65, 5120
    s_mov_b32 s66, 6144
    s_waitcnt vmcnt(8)
    buffer_store_dword v3, v8, s[44:47], s15 offen offset:128
    s_waitcnt vmcnt(1)
    s_barrier
Lpoll_15:
    buffer_load_dword v20, v19, s[44:47], s7 offen offset:128 sc1
    s_add_u32 s59, s59, 1
    s_cmp_gt_u32 s59, 0x100000
    s_cbranch_scc1 Lend
    s_waitcnt vmcnt(0)
    v_cmp_ne_u32 vcc, s53, v20
    s_cbranch_vccnz Lpoll_15
    s_add_u32 m0, s58, 62464
    s_lshl1_add_u32 s4, s17, 0
    buffer_load_dwordx4 v7, s[44:47], s4 offen sc1 lds
    s_add_u32 m0, s58, 66560
    s_lshl1_add_u32 s4, s18, 0
    buffer_load_dwordx4 v7, s[44:47], s4 offen sc1 lds
    s_add_u32 m0, s58, 70656
    s_lshl1_add_u32 s4, s19, 0
    buffer_load_dwordx4 v7, s[44:47], s4 offen sc1 lds
    s_add_u32 m0, s58, 74752
    s_lshl1_add_u32 s4, s8, 0
    buffer_load_dwordx4 v7, s[44:47], s4 offen sc1 lds
    s_cmp_eq_u32 s48, 3
    s_cselect_b32 exec_hi, 0, -1
    s_add_u32 m0, s58, 57344
    s_add_u32 s5, s12, 61440
    buffer_load_dwordx4 v1, s[44:47], s5 offen sc1 lds
    s_add_u32 s4, s58, 159744
    s_cmp_eq_u32 s48, 0
    s_cselect_b32 m0, 61440, s4
    s_add_u32 s5, s50, 61440
    buffer_load_dwordx4 v1, s[44:47], s5 offen sc1 lds
    s_mov_b64 exec, -1
    s_add_u32 m0, s58, 78848
    s_lshl1_add_u32 s4, s3, 0
    buffer_load_dwordx4 v7, s[44:47], s4 offen sc1 lds
    s_add_u32 m0, s58, 82944
    s_lshl1_add_u32 s4, s57, 0
    buffer_load_dwordx4 v7, s[44:47], s4 offen sc1 lds
    s_add_u32 m0, s58, 87040
    s_lshl1_add_u32 s4, s9, 0
    buffer_load_dwordx4 v7, s[44:47], s4 offen sc1 lds
    s_add_u32 m0, s51, 163200
    s_mov_b64 exec, 1
    buffer_load_dword v2, s[44:47], s15 offen offset:128 sc1 lds
    s_mov_b64 exec, -1
    s_add_u32 m0, s58, 91136
    s_lshl1_add_u32 s4, s17, 28672
    buffer_load_dwordx4 v7, s[44:47], s4 offen sc1 lds
    s_add_u32 m0, s58, 95232
    s_lshl1_add_u32 s4, s18, 28672
    buffer_load_dwordx4 v7, s[44:47], s4 offen sc1 lds
    s_add_u32 m0, s58, 99328
    s_lshl1_add_u32 s4, s19, 28672
    buffer_load_dwordx4 v7, s[44:47], s4 offen sc1 lds
    s_waitcnt vmcnt(7)
    s_barrier
    s_setprio 0
    s_add_u32 m0, s58, 103424
    s_lshl1_add_u32 s4, s8, 28672
    buffer_load_dwordx4 v7, s[44:47], s4 offen sc1 lds
    s_add_u32 m0, s58, 107520
    s_lshl1_add_u32 s4, s3, 28672
    buffer_load_dwordx4 v7, s[44:47], s4 offen sc1 lds
    s_add_u32 m0, s58, 111616
    s_lshl1_add_u32 s4, s57, 28672
    buffer_load_dwordx4 v7, s[44:47], s4 offen sc1 lds
    s_add_u32 m0, s58, 115712
    s_lshl1_add_u32 s4, s9, 28672
    buffer_load_dwordx4 v7, s[44:47], s4 offen sc1 lds
    s_add_u32 m0, s51, 163216
    s_mov_b64 exec, 1
    buffer_load_dword v2, s[44:47], s15 offen offset:128 sc1 lds
    s_mov_b64 exec, -1
    s_add_u32 m0, s58, 0
    s_lshl1_add_u32 s4, s17, 0
    buffer_load_dwordx4 v21, s[44:47], s4 offen sc1 lds
    s_add_u32 m0, s58, 4096
    s_lshl1_add_u32 s4, s18, 0
    buffer_load_dwordx4 v21, s[44:47], s4 offen sc1 lds
    s_add_u32 m0, s58, 8192
    s_lshl1_add_u32 s4, s19, 0
    buffer_load_dwordx4 v21, s[44:47], s4 offen sc1 lds
    s_add_u32 m0, s58, 12288
    s_lshl1_add_u32 s4, s8, 0
    buffer_load_dwordx4 v21, s[44:47], s4 offen sc1 lds
    s_add_u32 m0, s58, 16384
    s_lshl1_add_u32 s4, s3, 0
    buffer_load_dwordx4 v21, s[44:47], s4 offen sc1 lds
    s_add_u32 m0, s58, 20480
    s_lshl1_add_u32 s4, s57, 0
    buffer_load_dwordx4 v21, s[44:47], s4 offen sc1 lds
    s_add_u32 m0, s58, 24576
    s_lshl1_add_u32 s4, s9, 0
    buffer_load_dwordx4 v21, s[44:47], s4 offen sc1 lds
    s_add_u32 m0, s51, 163232
    s_mov_b64 exec, 1
    buffer_load_dword v2, s[44:47], s15 offen offset:128 sc1 lds
    s_mov_b64 exec, -1
    v_min_u32 v10, 2, v0
    s_mul_i32 s4, s48, 384
    v_lshl_add_u32 v10, v10, 7, s4
    s_mov_b32 s6, 0
    s_add_u32 m0, s16, 16384
    s_nop 0
    buffer_load_dwordx4 v11, s[36:39], s6 offen offset:0  lds
    s_add_u32 m0, s58, 28672
    s_lshl1_add_u32 s4, s17, 28672
    buffer_load_dwordx4 v21, s[44:47], s4 offen sc1 lds
    s_add_u32 m0, s58, 32768
    s_lshl1_add_u32 s4, s18, 28672
    buffer_load_dwordx4 v21, s[44:47], s4 offen sc1 lds
    s_add_u32 m0, s58, 36864
    s_lshl1_add_u32 s4, s19, 28672
    buffer_load_dwordx4 v21, s[44:47], s4 offen sc1 lds
    s_add_u32 m0, s58, 40960
    s_lshl1_add_u32 s4, s8, 28672
    buffer_load_dwordx4 v21, s[44:47], s4 offen sc1 lds
    s_add_u32 m0, s58, 45056
    s_lshl1_add_u32 s4, s3, 28672
    buffer_load_dwordx4 v21, s[44:47], s4 offen sc1 lds
    s_add_u32 m0, s58, 49152
    s_lshl1_add_u32 s4, s57, 28672
    buffer_load_dwordx4 v21, s[44:47], s4 offen sc1 lds
    s_add_u32 m0, s58, 53248
    s_lshl1_add_u32 s4, s9, 28672
    buffer_load_dwordx4 v21, s[44:47], s4 offen sc1 lds
    s_add_u32 m0, s51, 163248
    s_mov_b64 exec, 1
    buffer_load_dword v2, s[44:47], s15 offen offset:128 sc1 lds
    s_mov_b64 exec, -1
    s_add_u32 m0, s16, 16384
    s_nop 0
    buffer_load_dwordx4 v12, s[36:39], s6 offen offset:1024  lds
    s_mov_b32 s6, 114688
    s_add_u32 m0, s16, 24576
    s_nop 0
    buffer_load_dwordx4 v11, s[36:39], s6 offen offset:0  lds
    s_add_u32 m0, s16, 24576
    s_nop 0
    buffer_load_dwordx4 v12, s[36:39], s6 offen offset:1024  lds
    s_mov_b32 s6, 229376
    s_add_u32 m0, s16, 32768
    s_nop 0
    buffer_load_dwordx4 v11, s[36:39], s6 offen offset:0  lds
    s_add_u32 m0, s16, 32768
    s_nop 0
    buffer_load_dwordx4 v12, s[36:39], s6 offen offset:1024  lds
    s_mov_b32 s6, 344064
    s_add_u32 m0, s16, 0
    s_nop 0
    buffer_load_dwordx4 v11, s[36:39], s6 offen offset:0  lds
    buffer_load_dword v88, v10, s[44:47], s54 offen offset:512 sc1
    s_waitcnt vmcnt(15)
    ds_read_b64_tr_b16 v[144:145], v13 offset:16384
    ds_read_b64_tr_b16 v[148:149], v14 offset:16384
    s_add_u32 m0, s16, 0
    s_nop 0
    buffer_load_dwordx4 v12, s[36:39], s6 offen offset:1024  lds
    s_waitcnt vmcnt(7)
    ds_read_b64_tr_b16 v[146:147], v13 offset:17408
    ds_read_b64_tr_b16 v[150:151], v14 offset:17408
    s_mov_b32 s6, 458752
    s_add_u32 m0, s16, 8192
    s_nop 0
    buffer_load_dwordx4 v11, s[36:39], s6 offen offset:0  lds
    s_waitcnt vmcnt(7)
    ds_read_b64_tr_b16 v[152:153], v13 offset:24576
    ds_read_b64_tr_b16 v[156:157], v14 offset:24576
    s_add_u32 m0, s16, 8192
    s_nop 0
    buffer_load_dwordx4 v12, s[36:39], s6 offen offset:1024  lds
    s_waitcnt vmcnt(7)
    ds_read_b64_tr_b16 v[154:155], v13 offset:25600
    ds_read_b64_tr_b16 v[158:159], v14 offset:25600
    s_waitcnt lgkmcnt(6)
    s_mov_b32 s6, 573440
    s_add_u32 m0, s16, 16384
    s_nop 0
    buffer_load_dwordx4 v11, s[36:39], s6 offen offset:0  lds
    s_waitcnt vmcnt(7)
    ds_read_b64_tr_b16 v[160:161], v13 offset:32768
    ds_read_b64_tr_b16 v[164:165], v14 offset:32768
    s_waitcnt lgkmcnt(6)
    s_add_u32 m0, s16, 16384
    s_nop 0
    buffer_load_dwordx4 v12, s[36:39], s6 offen offset:1024  lds
    s_waitcnt vmcnt(7)
    ds_read_b64_tr_b16 v[162:163], v13 offset:33792
    ds_read_b64_tr_b16 v[166:167], v14 offset:33792
    s_waitcnt lgkmcnt(6)
    s_mov_b32 s6, 688128
    s_add_u32 m0, s16, 24576
    s_nop 0
    buffer_load_dwordx4 v11, s[36:39], s6 offen offset:0  lds
    s_waitcnt vmcnt(7)
    ds_read_b64_tr_b16 v[168:169], v13 offset:0
    ds_read_b64_tr_b16 v[172:173], v14 offset:0
    s_waitcnt lgkmcnt(6)
    s_add_u32 m0, s16, 24576
    s_nop 0
    buffer_load_dwordx4 v12, s[36:39], s6 offen offset:1024  lds
    s_waitcnt vmcnt(6)
    ds_read_b64_tr_b16 v[170:171], v13 offset:1024
    ds_read_b64_tr_b16 v[174:175], v14 offset:1024
    s_waitcnt lgkmcnt(6)
    s_mov_b32 s6, 14336
    s_add_u32 m0, s16, 32768
    s_nop 0
    buffer_load_dwordx4 v11, s[36:39], s6 offen offset:0  lds
    s_waitcnt vmcnt(6)
    ds_read_b64_tr_b16 v[176:177], v13 offset:8192
    ds_read_b64_tr_b16 v[180:181], v14 offset:8192
    s_waitcnt lgkmcnt(6)
    s_add_u32 m0, s16, 32768
    s_nop 0
    buffer_load_dwordx4 v12, s[36:39], s6 offen offset:1024  lds
    s_waitcnt vmcnt(6)
    ds_read_b64_tr_b16 v[178:179], v13 offset:9216
    ds_read_b64_tr_b16 v[182:183], v14 offset:9216
    s_waitcnt lgkmcnt(6)
    s_mov_b32 s6, 129024
    s_add_u32 m0, s16, 0
    s_nop 0
    buffer_load_dwordx4 v11, s[36:39], s6 offen offset:0  lds
    s_waitcnt vmcnt(6)
    ds_read_b64_tr_b16 v[184:185], v13 offset:16384
    ds_read_b64_tr_b16 v[188:189], v14 offset:16384
    s_waitcnt lgkmcnt(6)
    s_add_u32 m0, s16, 0
    s_nop 0
    buffer_load_dwordx4 v12, s[36:39], s6 offen offset:1024  lds
    s_waitcnt vmcnt(6)
    ds_read_b64_tr_b16 v[186:187], v13 offset:17408
    ds_read_b64_tr_b16 v[190:191], v14 offset:17408
    s_waitcnt lgkmcnt(6)
    s_mov_b32 s6, 243712
    s_add_u32 m0, s16, 8192
    s_nop 0
    buffer_load_dwordx4 v11, s[36:39], s6 offen offset:0  lds
    s_waitcnt vmcnt(6)
    ds_read_b64_tr_b16 v[192:193], v13 offset:24576
    ds_read_b64_tr_b16 v[196:197], v14 offset:24576
    s_waitcnt lgkmcnt(6)
    s_add_u32 m0, s16, 8192
    s_nop 0
    buffer_load_dwordx4 v12, s[36:39], s6 offen offset:1024  lds
    s_waitcnt vmcnt(6)
    ds_read_b64_tr_b16 v[194:195], v13 offset:25600
    ds_read_b64_tr_b16 v[198:199], v14 offset:25600
    s_waitcnt lgkmcnt(6)
    s_mov_b32 s6, 358400
    s_add_u32 m0, s16, 16384
    s_nop 0
    buffer_load_dwordx4 v11, s[36:39], s6 offen offset:0  lds
    s_waitcnt vmcnt(6)
    ds_read_b64_tr_b16 v[200:201], v13 offset:32768
    ds_read_b64_tr_b16 v[204:205], v14 offset:32768
    s_waitcnt lgkmcnt(6)
    s_add_u32 m0, s16, 16384
    s_nop 0
    buffer_load_dwordx4 v12, s[36:39], s6 offen offset:1024  lds
    s_waitcnt vmcnt(6)
    ds_read_b64_tr_b16 v[202:203], v13 offset:33792
    ds_read_b64_tr_b16 v[206:207], v14 offset:33792
    s_waitcnt lgkmcnt(6)
    s_mov_b32 s6, 473088
    s_add_u32 m0, s16, 24576
    s_nop 0
    buffer_load_dwordx4 v11, s[36:39], s6 offen offset:0  lds
    s_waitcnt vmcnt(6)
    ds_read_b64_tr_b16 v[208:209], v13 offset:0
    ds_read_b64_tr_b16 v[212:213], v14 offset:0
    s_waitcnt lgkmcnt(6)
    s_add_u32 m0, s16, 24576
    s_nop 0
    buffer_load_dwordx4 v12, s[36:39], s6 offen offset:1024  lds
    s_waitcnt vmcnt(6)
    ds_read_b64_tr_b16 v[210:211], v13 offset:1024
    ds_read_b64_tr_b16 v[214:215], v14 offset:1024
    s_waitcnt lgkmcnt(6)
    s_mov_b32 s6, 587776
    s_add_u32 m0, s16, 32768
    s_nop 0
    buffer_load_dwordx4 v11, s[36:39], s6 offen offset:0  lds
    buffer_load_dword v15, v9, s[44:47], s10 offen offset:512 sc1
    s_waitcnt vmcnt(7)
    ds_read_b64_tr_b16 v[216:217], v13 offset:8192
    ds_read_b64_tr_b16 v[220:221], v14 offset:8192
    s_waitcnt lgkmcnt(6)
    s_add_u32 m0, s16, 32768
    s_nop 0
    buffer_load_dwordx4 v12, s[36:39], s6 offen offset:1024  lds
    s_waitcnt vmcnt(7)
    ds_read_b64_tr_b16 v[218:219], v13 offset:9216
    ds_read_b64_tr_b16 v[222:223], v14 offset:9216
    s_waitcnt lgkmcnt(6)
    s_mov_b32 s6, 702464
    s_add_u32 m0, s16, 0
    s_nop 0
    buffer_load_dwordx4 v11, s[36:39], s6 offen offset:0  lds
    s_waitcnt vmcnt(7)
    ds_read_b64_tr_b16 v[224:225], v13 offset:16384
    ds_read_b64_tr_b16 v[228:229], v14 offset:16384
    s_waitcnt lgkmcnt(6)
    s_add_u32 m0, s16, 0
    s_nop 0
    buffer_load_dwordx4 v12, s[36:39], s6 offen offset:1024  lds
    s_waitcnt vmcnt(7)
    ds_read_b64_tr_b16 v[226:227], v13 offset:17408
    ds_read_b64_tr_b16 v[230:231], v14 offset:17408
    s_add_u32 s11, s53, 1
    s_waitcnt vmcnt(3)
    v_subrev_u32 v20, s11, v15
    v_cmp_le_u32 vcc, 15, v20
    s_cbranch_vccnz Lslowcnt_16
Lback_17:
    s_setprio 1
    buffer_load_dwordx4 v[88:91], v22, s[40:43], s60 offen sc1
    ds_read_b64_tr_b16 v[232:233], v13 offset:24576
    ds_read_b64_tr_b16 v[236:237], v14 offset:24576
    buffer_load_dwordx4 v[92:95], v22, s[40:43], s61 offen sc1
    ds_read_b64_tr_b16 v[234:235], v13 offset:25600
    ds_read_b64_tr_b16 v[238:239], v14 offset:25600
    buffer_load_dwordx4 v[96:99], v22, s[40:43], s62 offen sc1
    ds_read_b64_tr_b16 v[240:241], v13 offset:32768
    ds_read_b64_tr_b16 v[244:245], v14 offset:32768
    buffer_load_dwordx4 v[100:103], v22, s[40:43], s63 offen sc1
    s_waitcnt vmcnt(6)
    ds_read_b64_tr_b16 v[242:243], v13 offset:33792
    ds_read_b64_tr_b16 v[246:247], v14 offset:33792
    buffer_load_dwordx4 v[104:107], v22, s[40:43], s64 offen sc1
    s_waitcnt vmcnt(6)
    ds_read_b64_tr_b16 v[248:249], v13 offset:0
    ds_read_b64_tr_b16 v[252:253], v14 offset:0
    buffer_load_dwordx4 v[108:111], v22, s[40:43], s65 offen sc1
    s_waitcnt vmcnt(6)
    ds_read_b64_tr_b16 v[250:251], v13 offset:1024
    ds_read_b64_tr_b16 v[254:255], v14 offset:1024
    buffer_load_dwordx4 v[112:115], v22, s[40:43], s66 offen sc1
    v_add_u32 v22, 7168, v22
    buffer_load_dwordx4 v[116:119], v22, s[40:43], s60 offen sc1
    s_waitcnt lgkmcnt(0)
    v_subrev_u32 v11, 57344, v16
    v_subrev_u32 v12, 57344, v17
    v_subrev_u32 v13, 57344, v18
    v_subrev_u32 v14, 57344, v23
    s_waitcnt vmcnt(7)
    v_mfma_f32_32x32x16_bf16 v[24:39], v[144:147], v[88:91], 0
    buffer_load_dwordx4 v[120:123], v22, s[40:43], s61 offen sc1
    buffer_load_dword v10, v9, s[44:47], s10 offen offset:512 sc1
    s_waitcnt vmcnt(8)
    v_mfma_f32_32x32x16_bf16 v[24:39], v[152:155], v[92:95], v[24:39]
    buffer_load_dwordx4 v[124:127], v22, s[40:43], s62 offen sc1
    s_waitcnt vmcnt(8)
    v_mfma_f32_32x32x16_bf16 v[24:39], v[160:163], v[96:99], v[24:39]
    buffer_load_dwordx4 v[128:131], v22, s[40:43], s63 offen sc1
    s_waitcnt vmcnt(8)
    v_mfma_f32_32x32x16_bf16 v[24:39], v[168:171], v[100:103], v[24:39]
    buffer_load_dwordx4 v[132:135], v22, s[40:43], s64 offen sc1
    s_waitcnt vmcnt(8)
    v_mfma_f32_32x32x16_bf16 v[24:39], v[176:179], v[104:107], v[24:39]
    buffer_load_dwordx4 v[136:139], v22, s[40:43], s65 offen sc1
    s_waitcnt vmcnt(8)
    v_mfma_f32_32x32x16_bf16 v[24:39], v[184:187], v[108:111], v[24:39]
    buffer_load_dwordx4 v[140:143], v22, s[40:43], s66 offen sc1
    v_mfma_f32_32x32x16_bf16 v[40:55], v[148:151], v[88:91], 0
    s_waitcnt vmcnt(8)
    v_mfma_f32_32x32x16_bf16 v[24:39], v[192:195], v[112:115], v[24:39]
    s_add_u32 s11, s53, 3
    s_waitcnt vmcnt(5)
    v_subrev_u32 v20, s11, v10
    v_cmp_le_u32 vcc, 13, v20
    s_cbranch_vccnz Lslowcnt_18
Lback_19:
    buffer_load_dwordx4 v[88:91], v4, s[44:47], s60 offen sc1
    v_mfma_f32_32x32x16_bf16 v[40:55], v[156:159], v[92:95], v[40:55]
    v_mfma_f32_32x32x16_bf16 v[24:39], v[200:203], v[116:119], v[24:39]
    buffer_load_dwordx4 v[92:95], v4, s[44:47], s61 offen sc1
    v_mfma_f32_32x32x16_bf16 v[40:55], v[164:167], v[96:99], v[40:55]
    v_mfma_f32_32x32x16_bf16 v[24:39], v[208:211], v[120:123], v[24:39]
    buffer_load_dwordx4 v[96:99], v4, s[44:47], s62 offen sc1
    v_mfma_f32_32x32x16_bf16 v[40:55], v[172:175], v[100:103], v[40:55]
    s_waitcnt vmcnt(7)
    v_mfma_f32_32x32x16_bf16 v[24:39], v[216:219], v[124:127], v[24:39]
    buffer_load_dwordx4 v[100:103], v4, s[44:47], s63 offen sc1
    v_mfma_f32_32x32x16_bf16 v[40:55], v[180:183], v[104:107], v[40:55]
    s_waitcnt vmcnt(7)
    v_mfma_f32_32x32x16_bf16 v[24:39], v[224:227], v[128:131], v[24:39]
    buffer_load_dwordx4 v[104:107], v4, s[44:47], s64 offen sc1
    v_mfma_f32_32x32x16_bf16 v[40:55], v[188:191], v[108:111], v[40:55]
    s_waitcnt vmcnt(7)
    v_mfma_f32_32x32x16_bf16 v[24:39], v[232:235], v[132:135], v[24:39]
    buffer_load_dwordx4 v[108:111], v4, s[44:47], s65 offen sc1
    buffer_load_dword v10, v9, s[44:47], s10 offen offset:512 sc1
    v_mfma_f32_32x32x16_bf16 v[40:55], v[196:199], v[112:115], v[40:55]
    s_waitcnt vmcnt(8)
    v_mfma_f32_32x32x16_bf16 v[24:39], v[240:243], v[136:139], v[24:39]
    buffer_load_dwordx4 v[112:115], v4, s[44:47], s66 offen sc1
    v_mfma_f32_32x32x16_bf16 v[40:55], v[204:207], v[116:119], v[40:55]
    s_waitcnt vmcnt(8)
    v_mfma_f32_32x32x16_bf16 v[24:39], v[248:251], v[140:143], v[24:39]
    buffer_store_dword v3, v8, s[44:47], s15 offen offset:1920
    v_add_u32 v4, 7168, v4
    buffer_load_dwordx4 v[116:119], v4, s[44:47], s60 offen sc1
    v_mfma_f32_32x32x16_bf16 v[40:55], v[212:215], v[120:123], v[40:55]
    s_waitcnt vmcnt(9)
    v_mfma_f32_32x32x16_bf16 v[56:71], v[144:147], v[88:91], 0
    buffer_load_dwordx4 v[120:123], v4, s[44:47], s61 offen sc1
    v_mfma_f32_32x32x16_bf16 v[40:55], v[220:223], v[124:127], v[40:55]
    s_waitcnt vmcnt(9)
    v_mfma_f32_32x32x16_bf16 v[56:71], v[152:155], v[92:95], v[56:71]
    buffer_load_dwordx4 v[124:127], v4, s[44:47], s62 offen sc1
    v_mfma_f32_32x32x16_bf16 v[40:55], v[228:231], v[128:131], v[40:55]
    ds_write_b128 v16, v[24:27] offset:0
    s_waitcnt vmcnt(9)
    v_mfma_f32_32x32x16_bf16 v[56:71], v[160:163], v[96:99], v[56:71]
    buffer_load_dwordx4 v[128:131], v4, s[44:47], s63 offen sc1
    v_mfma_f32_32x32x16_bf16 v[40:55], v[236:239], v[132:135], v[40:55]
    ds_write_b128 v17, v[28:31] offset:0
    s_waitcnt vmcnt(9)
    v_mfma_f32_32x32x16_bf16 v[56:71], v[168:171], v[100:103], v[56:71]
    buffer_load_dwordx4 v[132:135], v4, s[44:47], s64 offen sc1
    v_mfma_f32_32x32x16_bf16 v[40:55], v[244:247], v[136:139], v[40:55]
    ds_write_b128 v18, v[32:35] offset:0
    s_waitcnt vmcnt(9)
    v_mfma_f32_32x32x16_bf16 v[56:71], v[176:179], v[104:107], v[56:71]
    buffer_load_dwordx4 v[136:139], v4, s[44:47], s65 offen sc1
    v_mfma_f32_32x32x16_bf16 v[40:55], v[252:255], v[140:143], v[40:55]
    ds_write_b128 v23, v[36:39] offset:0
    s_waitcnt vmcnt(9)
    v_mfma_f32_32x32x16_bf16 v[56:71], v[184:187], v[108:111], v[56:71]
    buffer_load_dwordx4 v[140:143], v4, s[44:47], s66 offen sc1
    v_mfma_f32_32x32x16_bf16 v[72:87], v[148:151], v[88:91], 0
    s_waitcnt vmcnt(8)
    v_mfma_f32_32x32x16_bf16 v[56:71], v[192:195], v[112:115], v[56:71]
    s_add_u32 s11, s53, 5
    v_subrev_u32 v20, s11, v10
    v_cmp_le_u32 vcc, 11, v20
    s_cbranch_vccnz Lslowcnt_20
Lback_21:
    buffer_load_dwordx4 v[88:91], v5, s[44:47], s60 offen sc1
    v_mfma_f32_32x32x16_bf16 v[72:87], v[156:159], v[92:95], v[72:87]
    ds_write_b128 v16, v[40:43] offset:128
    s_waitcnt vmcnt(7)
    v_mfma_f32_32x32x16_bf16 v[56:71], v[200:203], v[116:119], v[56:71]
    buffer_load_dwordx4 v[92:95], v5, s[44:47], s61 offen sc1
    v_mfma_f32_32x32x16_bf16 v[72:87], v[164:167], v[96:99], v[72:87]
    ds_write_b128 v17, v[44:47] offset:128
    s_waitcnt vmcnt(7)
    v_mfma_f32_32x32x16_bf16 v[56:71], v[208:211], v[120:123], v[56:71]
    buffer_load_dwordx4 v[96:99], v5, s[44:47], s62 offen sc1
    v_mfma_f32_32x32x16_bf16 v[72:87], v[172:175], v[100:103], v[72:87]
    ds_write_b128 v18, v[48:51] offset:128
    s_waitcnt vmcnt(7)
    v_mfma_f32_32x32x16_bf16 v[56:71], v[216:219], v[124:127], v[56:71]
    buffer_load_dwordx4 v[100:103], v5, s[44:47], s63 offen sc1
    v_mfma_f32_32x32x16_bf16 v[72:87], v[180:183], v[104:107], v[72:87]
    ds_write_b128 v23, v[52:55] offset:128
    s_waitcnt vmcnt(7)
    v_mfma_f32_32x32x16_bf16 v[56:71], v[224:227], v[128:131], v[56:71]
    buffer_load_dwordx4 v[104:107], v5, s[44:47], s64 offen sc1
    v_mfma_f32_32x32x16_bf16 v[72:87], v[188:191], v[108:111], v[72:87]
    s_waitcnt vmcnt(7)
    v_mfma_f32_32x32x16_bf16 v[56:71], v[232:235], v[132:135], v[56:71]
    buffer_load_dwordx4 v[108:111], v5, s[44:47], s65 offen sc1
    buffer_load_dword v10, v9, s[44:47], s10 offen offset:512 sc1
    v_mfma_f32_32x32x16_bf16 v[72:87], v[196:199], v[112:115], v[72:87]
    s_waitcnt lgkmcnt(0)
    s_barrier
    s_waitcnt vmcnt(8)
    v_mfma_f32_32x32x16_bf16 v[56:71], v[240:243], v[136:139], v[56:71]
    buffer_load_dwordx4 v[112:115], v5, s[44:47], s66 offen sc1
    v_mfma_f32_32x32x16_bf16 v[72:87], v[204:207], v[116:119], v[72:87]
    s_waitcnt vmcnt(8)
    v_mfma_f32_32x32x16_bf16 v[56:71], v[248:251], v[140:143], v[56:71]
    v_add_u32 v5, 7168, v5
    buffer_load_dwordx4 v[116:119], v5, s[44:47], s60 offen sc1
    v_mfma_f32_32x32x16_bf16 v[72:87], v[212:215], v[120:123], v[72:87]
    s_waitcnt vmcnt(8)
    v_mfma_f32_32x32x16_bf16 v[24:39], v[144:147], v[88:91], 0
    buffer_load_dwordx4 v[120:123], v5, s[44:47], s61 offen sc1
    v_mfma_f32_32x32x16_bf16 v[72:87], v[220:223], v[124:127], v[72:87]
    s_waitcnt vmcnt(8)
    v_mfma_f32_32x32x16_bf16 v[24:39], v[152:155], v[92:95], v[24:39]
    buffer_load_dwordx4 v[124:127], v5, s[44:47], s62 offen sc1
    v_mfma_f32_32x32x16_bf16 v[72:87], v[228:231], v[128:131], v[72:87]
    s_nop 0
    ds_write_b128 v11, v[56:59] offset:0
    s_waitcnt vmcnt(8)
    v_mfma_f32_32x32x16_bf16 v[24:39], v[160:163], v[96:99], v[24:39]
    buffer_load_dwordx4 v[128:131], v5, s[44:47], s63 offen sc1
    v_mfma_f32_32x32x16_bf16 v[72:87], v[236:239], v[132:135], v[72:87]
    ds_write_b128 v12, v[60:63] offset:0
    s_waitcnt vmcnt(8)
    v_mfma_f32_32x32x16_bf16 v[24:39], v[168:171], v[100:103], v[24:39]
    buffer_load_dwordx4 v[132:135], v5, s[44:47], s64 offen sc1
    v_mfma_f32_32x32x16_bf16 v[72:87], v[244:247], v[136:139], v[72:87]
    ds_write_b128 v13, v[64:67] offset:0
    s_waitcnt vmcnt(8)
    v_mfma_f32_32x32x16_bf16 v[24:39], v[176:179], v[104:107], v[24:39]
    buffer_load_dwordx4 v[136:139], v5, s[44:47], s65 offen sc1
    v_mfma_f32_32x32x16_bf16 v[72:87], v[252:255], v[140:143], v[72:87]
    ds_write_b128 v14, v[68:71] offset:0
    s_waitcnt vmcnt(8)
    v_mfma_f32_32x32x16_bf16 v[24:39], v[184:187], v[108:111], v[24:39]
    buffer_load_dwordx4 v[140:143], v5, s[44:47], s66 offen sc1
    v_mfma_f32_32x32x16_bf16 v[40:55], v[148:151], v[88:91], 0
    s_waitcnt vmcnt(7)
    v_mfma_f32_32x32x16_bf16 v[24:39], v[192:195], v[112:115], v[24:39]
    s_add_u32 s11, s53, 7
    v_subrev_u32 v20, s11, v10
    v_cmp_le_u32 vcc, 9, v20
    s_cbranch_vccnz Lslowcnt_22
Lback_23:
    buffer_load_dwordx4 v[88:91], v6, s[44:47], s60 offen sc1
    v_mfma_f32_32x32x16_bf16 v[40:55], v[156:159], v[92:95], v[40:55]
    ds_write_b128 v11, v[72:75] offset:128
    s_waitcnt vmcnt(7)
    v_mfma_f32_32x32x16_bf16 v[24:39], v[200:203], v[116:119], v[24:39]
    buffer_load_dwordx4 v[92:95], v6, s[44:47], s61 offen sc1
    v_mfma_f32_32x32x16_bf16 v[40:55], v[164:167], v[96:99], v[40:55]
    ds_write_b128 v12, v[76:79] offset:128
    s_waitcnt vmcnt(7)
    v_mfma_f32_32x32x16_bf16 v[24:39], v[208:211], v[120:123], v[24:39]
    buffer_load_dwordx4 v[96:99], v6, s[44:47], s62 offen sc1
    v_mfma_f32_32x32x16_bf16 v[40:55], v[172:175], v[100:103], v[40:55]
    ds_write_b128 v13, v[80:83] offset:128
    s_waitcnt vmcnt(7)
    v_mfma_f32_32x32x16_bf16 v[24:39], v[216:219], v[124:127], v[24:39]
    buffer_load_dwordx4 v[100:103], v6, s[44:47], s63 offen sc1
    v_mfma_f32_32x32x16_bf16 v[40:55], v[180:183], v[104:107], v[40:55]
    ds_write_b128 v14, v[84:87] offset:128
    s_waitcnt vmcnt(7)
    v_mfma_f32_32x32x16_bf16 v[24:39], v[224:227], v[128:131], v[24:39]
    buffer_load_dwordx4 v[104:107], v6, s[44:47], s64 offen sc1
    v_mfma_f32_32x32x16_bf16 v[40:55], v[188:191], v[108:111], v[40:55]
    s_waitcnt vmcnt(7)
    v_mfma_f32_32x32x16_bf16 v[24:39], v[232:235], v[132:135], v[24:39]
    buffer_load_dwordx4 v[108:111], v6, s[44:47], s65 offen sc1
    v_mfma_f32_32x32x16_bf16 v[40:55], v[196:199], v[112:115], v[40:55]
    s_waitcnt lgkmcnt(0)
    s_barrier
    s_waitcnt vmcnt(7)
    v_mfma_f32_32x32x16_bf16 v[24:39], v[240:243], v[136:139], v[24:39]
    buffer_load_dwordx4 v[112:115], v6, s[44:47], s66 offen sc1
    v_mfma_f32_32x32x16_bf16 v[40:55], v[204:207], v[116:119], v[40:55]
    s_waitcnt vmcnt(7)
    v_mfma_f32_32x32x16_bf16 v[24:39], v[248:251], v[140:143], v[24:39]
    v_add_u32 v6, 7168, v6
    buffer_load_dwordx4 v[116:119], v6, s[44:47], s60 offen sc1
    v_mfma_f32_32x32x16_bf16 v[40:55], v[212:215], v[120:123], v[40:55]
    s_waitcnt vmcnt(7)
    v_mfma_f32_32x32x16_bf16 v[56:71], v[144:147], v[88:91], 0
    buffer_load_dwordx4 v[120:123], v6, s[44:47], s61 offen sc1
    v_mfma_f32_32x32x16_bf16 v[40:55], v[220:223], v[124:127], v[40:55]
    s_waitcnt vmcnt(7)
    v_mfma_f32_32x32x16_bf16 v[56:71], v[152:155], v[92:95], v[56:71]
    buffer_load_dwordx4 v[124:127], v6, s[44:47], s62 offen sc1
    v_mfma_f32_32x32x16_bf16 v[40:55], v[228:231], v[128:131], v[40:55]
    s_nop 0
    ds_write_b128 v16, v[24:27] offset:0
    s_waitcnt vmcnt(7)
    v_mfma_f32_32x32x16_bf16 v[56:71], v[160:163], v[96:99], v[56:71]
    buffer_load_dwordx4 v[128:131], v6, s[44:47], s63 offen sc1
    v_mfma_f32_32x32x16_bf16 v[40:55], v[236:239], v[132:135], v[40:55]
    ds_write_b128 v17, v[28:31] offset:0
    s_waitcnt vmcnt(7)
    v_mfma_f32_32x32x16_bf16 v[56:71], v[168:171], v[100:103], v[56:71]
    buffer_load_dwordx4 v[132:135], v6, s[44:47], s64 offen sc1
    v_mfma_f32_32x32x16_bf16 v[40:55], v[244:247], v[136:139], v[40:55]
    ds_write_b128 v18, v[32:35] offset:0
    s_waitcnt vmcnt(7)
    v_mfma_f32_32x32x16_bf16 v[56:71], v[176:179], v[104:107], v[56:71]
    buffer_load_dwordx4 v[136:139], v6, s[44:47], s65 offen sc1
    v_mfma_f32_32x32x16_bf16 v[40:55], v[252:255], v[140:143], v[40:55]
    ds_write_b128 v23, v[36:39] offset:0
    s_waitcnt vmcnt(7)
    v_mfma_f32_32x32x16_bf16 v[56:71], v[184:187], v[108:111], v[56:71]
    buffer_load_dwordx4 v[140:143], v6, s[44:47], s66 offen sc1
    v_mfma_f32_32x32x16_bf16 v[72:87], v[148:151], v[88:91], 0
    s_waitcnt vmcnt(7)
    v_mfma_f32_32x32x16_bf16 v[56:71], v[192:195], v[112:115], v[56:71]
    v_mfma_f32_32x32x16_bf16 v[72:87], v[156:159], v[92:95], v[72:87]
    s_nop 3
    ds_write_b128 v16, v[40:43] offset:128
    s_waitcnt vmcnt(6)
    v_mfma_f32_32x32x16_bf16 v[56:71], v[200:203], v[116:119], v[56:71]
    v_mfma_f32_32x32x16_bf16 v[72:87], v[164:167], v[96:99], v[72:87]
    ds_write_b128 v17, v[44:47] offset:128
    s_waitcnt vmcnt(5)
    v_mfma_f32_32x32x16_bf16 v[56:71], v[208:211], v[120:123], v[56:71]
    v_mfma_f32_32x32x16_bf16 v[72:87], v[172:175], v[100:103], v[72:87]
    ds_write_b128 v18, v[48:51] offset:128
    s_waitcnt vmcnt(4)
    v_mfma_f32_32x32x16_bf16 v[56:71], v[216:219], v[124:127], v[56:71]
    v_mfma_f32_32x32x16_bf16 v[72:87], v[180:183], v[104:107], v[72:87]
    ds_write_b128 v23, v[52:55] offset:128
    s_waitcnt vmcnt(3)
    v_mfma_f32_32x32x16_bf16 v[56:71], v[224:227], v[128:131], v[56:71]
    v_mfma_f32_32x32x16_bf16 v[72:87], v[188:191], v[108:111], v[72:87]
    s_waitcnt vmcnt(2)
    v_mfma_f32_32x32x16_bf16 v[56:71], v[232:235], v[132:135], v[56:71]
    v_mfma_f32_32x32x16_bf16 v[72:87], v[196:199], v[112:115], v[72:87]
    s_waitcnt lgkmcnt(0)
    s_barrier
    s_waitcnt vmcnt(1)
    v_mfma_f32_32x32x16_bf16 v[56:71], v[240:243], v[136:139], v[56:71]
    v_mfma_f32_32x32x16_bf16 v[72:87], v[204:207], v[116:119], v[72:87]
    s_waitcnt vmcnt(0)
    v_mfma_f32_32x32x16_bf16 v[56:71], v[248:251], v[140:143], v[56:71]
    v_mfma_f32_32x32x16_bf16 v[72:87], v[212:215], v[120:123], v[72:87]
    v_mfma_f32_32x32x16_bf16 v[72:87], v[220:223], v[124:127], v[72:87]
    v_mfma_f32_32x32x16_bf16 v[72:87], v[228:231], v[128:131], v[72:87]
    s_nop 8
    ds_write_b128 v11, v[56:59] offset:0
    v_mfma_f32_32x32x16_bf16 v[72:87], v[236:239], v[132:135], v[72:87]
    ds_write_b128 v12, v[60:63] offset:0
    v_mfma_f32_32x32x16_bf16 v[72:87], v[244:247], v[136:139], v[72:87]
    ds_write_b128 v13, v[64:67] offset:0
    v_mfma_f32_32x32x16_bf16 v[72:87], v[252:255], v[140:143], v[72:87]
    ds_write_b128 v14, v[68:71] offset:0
    s_or_b32 s4, s52, s49
    s_or_b32 s4, s4, s48
    s_min_u32 s4, s4, 1
    s_lshl_b32 s4, s4, 31
    v_or_b32 v20, s4, v8
    buffer_store_dword v3, v20, s[44:47], s54 offen offset:384
    s_nop 4
    ds_write_b128 v11, v[72:75] offset:128
    ds_write_b128 v12, v[76:79] offset:128
    ds_write_b128 v13, v[80:83] offset:128
    ds_write_b128 v14, v[84:87] offset:128
    s_waitcnt lgkmcnt(0)
    s_barrier
    s_endpgm
Lhelper:
    s_mov_b32 s48, s58
    s_add_u32 s50, s50, s49
    s_mov_b64 s[32:33], s[10:11]
    s_mov_b32 s34, 1605632
    s_mov_b32 s35, 0x20000
    s_mov_b64 s[36:37], s[12:13]
    s_mov_b32 s38, 1605632
    s_mov_b32 s39, 0x20000
    s_mov_b64 s[44:45], s[18:19]
    s_mov_b32 s46, 16777216
    s_mov_b32 s47, 0x20000
    s_mov_b64 s[40:41], s[14:15]
    s_mov_b32 s42, 1835008
    s_mov_b32 s43, 0x20000
    s_xor_b32 s51, s50, 1
    s_and_b32 s52, s50, 1
    s_lshl_b32 s54, s50, 19
    s_lshl_b32 s55, s51, 19
    s_mov_b32 s59, 0
    v_lshlrev_b32 v1, 4, v0
    v_mov_b32 v2, 0
    s_cmp_ge_u32 s48, 4
    s_cbranch_scc1 Lend
    v_lshlrev_b32 v12, 7, v0
    s_mul_i32 s5, s48, 896
    s_add_u32 s5, s5, s54
    v_min_u32 v11, 768, v12
    buffer_load_dword v24, v11, s[44:47], s5 offen
    s_and_b32 s8, s2, 31
    s_mul_i32 s8, s8, 50176
    s_mul_i32 s5, s48, 12544
    s_add_u32 s5, s5, s8
    v_min_u32 v11, 1664, v12
    buffer_load_dword v24, v11, s[32:35], s5 offen
    s_add_u32 s5, s5, 1792
    buffer_load_dword v24, v11, s[32:35], s5 offen
    s_add_u32 s5, s5, 1792
    buffer_load_dword v24, v11, s[32:35], s5 offen
    s_add_u32 s5, s5, 1792
    buffer_load_dword v24, v11, s[32:35], s5 offen
    s_add_u32 s5, s5, 1792
    buffer_load_dword v24, v11, s[32:35], s5 offen
    s_add_u32 s5, s5, 1792
    buffer_load_dword v24, v11, s[32:35], s5 offen
    s_add_u32 s5, s5, 1792
    buffer_load_dword v24, v11, s[32:35], s5 offen
    s_mul_i32 s8, s50, 57344
    s_mul_i32 s5, s48, 14336
    s_add_u32 s5, s5, s8
    v_min_u32 v11, 1664, v12
    buffer_load_dword v24, v11, s[40:43], s5 offen
    s_add_u32 s5, s5, 1792
    buffer_load_dword v24, v11, s[40:43], s5 offen
    s_add_u32 s5, s5, 1792
    buffer_load_dword v24, v11, s[40:43], s5 offen
    s_add_u32 s5, s5, 1792
    buffer_load_dword v24, v11, s[40:43], s5 offen
    s_add_u32 s5, s5, 1792
    buffer_load_dword v24, v11, s[40:43], s5 offen
    s_add_u32 s5, s5, 1792
    buffer_load_dword v24, v11, s[40:43], s5 offen
    s_add_u32 s5, s5, 1792
    buffer_load_dword v24, v11, s[40:43], s5 offen
    s_add_u32 s5, s5, 1792
    buffer_load_dword v24, v11, s[40:43], s5 offen
    s_add_u32 s8, s54, 4096
    s_mul_i32 s5, s48, 15232
    s_add_u32 s5, s5, s8
    v_min_u32 v11, 1664, v12
    buffer_load_dword v24, v11, s[44:47], s5 offen
    s_add_u32 s5, s5, 1792
    buffer_load_dword v24, v11, s[44:47], s5 offen
    s_add_u32 s5, s5, 1792
    buffer_load_dword v24, v11, s[44:47], s5 offen
    s_add_u32 s5, s5, 1792
    buffer_load_dword v24, v11, s[44:47], s5 offen
    s_add_u32 s5, s5, 1792
    buffer_load_dword v24, v11, s[44:47], s5 offen
    s_add_u32 s5, s5, 1792
    buffer_load_dword v24, v11, s[44:47], s5 offen
    s_add_u32 s5, s5, 1792
    buffer_load_dword v24, v11, s[44:47], s5 offen
    s_add_u32 s5, s5, 1792
    buffer_load_dword v24, v11, s[44:47], s5 offen
    s_add_u32 s5, s5, 1792
    v_min_u32 v11, 768, v12
    buffer_load_dword v24, v11, s[44:47], s5 offen
    s_mul_i32 s8, s49, 28672
    s_add_u32 s8, s8, 1146880
    s_mul_i32 s5, s48, 7168
    s_add_u32 s5, s5, s8
    v_min_u32 v11, 1664, v12
    buffer_load_dword v24, v11, s[32:35], s5 offen
    s_add_u32 s5, s5, 1792
    buffer_load_dword v24, v11, s[32:35], s5 offen
    s_add_u32 s5, s5, 1792
    buffer_load_dword v24, v11, s[32:35], s5 offen
    s_add_u32 s5, s5, 1792
    buffer_load_dword v24, v11, s[32:35], s5 offen
    s_mul_i32 s8, s49, 28672
    s_add_u32 s8, s8, 1261568
    s_mul_i32 s5, s48, 7168
    s_add_u32 s5, s5, s8
    v_min_u32 v11, 1664, v12
    buffer_load_dword v24, v11, s[32:35], s5 offen
    s_add_u32 s5, s5, 1792
    buffer_load_dword v24, v11, s[32:35], s5 offen
    s_add_u32 s5, s5, 1792
    buffer_load_dword v24, v11, s[32:35], s5 offen
    s_add_u32 s5, s5, 1792
    buffer_load_dword v24, v11, s[32:35], s5 offen
    s_mul_i32 s8, s49, 28672
    s_add_u32 s8, s8, 1376256
    s_mul_i32 s5, s48, 7168
    s_add_u32 s5, s5, s8
    v_min_u32 v11, 1664, v12
    buffer_load_dword v24, v11, s[32:35], s5 offen
    s_add_u32 s5, s5, 1792
    buffer_load_dword v24, v11, s[32:35], s5 offen
    s_add_u32 s5, s5, 1792
    buffer_load_dword v24, v11, s[32:35], s5 offen
    s_add_u32 s5, s5, 1792
    buffer_load_dword v24, v11, s[32:35], s5 offen
    s_mul_i32 s8, s49, 28672
    s_add_u32 s8, s8, 1490944
    s_mul_i32 s5, s48, 7168
    s_add_u32 s5, s5, s8
    v_min_u32 v11, 1664, v12
    buffer_load_dword v24, v11, s[32:35], s5 offen
    s_add_u32 s5, s5, 1792
    buffer_load_dword v24, v11, s[32:35], s5 offen
    s_add_u32 s5, s5, 1792
    buffer_load_dword v24, v11, s[32:35], s5 offen
    s_add_u32 s5, s5, 1792
    buffer_load_dword v24, v11, s[32:35], s5 offen
    s_and_b32 s8, s2, 31
    s_mul_i32 s8, s8, 50176
    s_mul_i32 s5, s48, 12544
    s_add_u32 s5, s5, s8
    v_min_u32 v11, 1664, v12
    buffer_load_dword v24, v11, s[36:39], s5 offen
    s_add_u32 s5, s5, 1792
    buffer_load_dword v24, v11, s[36:39], s5 offen
    s_add_u32 s5, s5, 1792
    buffer_load_dword v24, v11, s[36:39], s5 offen
    s_add_u32 s5, s5, 1792
    buffer_load_dword v24, v11, s[36:39], s5 offen
    s_add_u32 s5, s5, 1792
    buffer_load_dword v24, v11, s[36:39], s5 offen
    s_add_u32 s5, s5, 1792
    buffer_load_dword v24, v11, s[36:39], s5 offen
    s_add_u32 s5, s5, 1792
    buffer_load_dword v24, v11, s[36:39], s5 offen
    s_waitcnt vmcnt(0)
    s_lshl2_add_u32 s8, s49, s48
    s_lshl_b32 s8, s8, 11
    v_min_u32 v11, 15, v0
    v_lshl_add_u32 v11, v11, 7, s8
    v_min_u32 v11, Lhot_end-Lpc-4, v11
    global_load_dword v24, v11, s[20:21] sc1
    s_endpgm
Lstslow:
    s_mov_b32 s4, 0
Lstslow1:
    ds_read_b64 v[144:145], v17 offset:60928
    ds_read_b64 v[146:147], v17 offset:61056
    ds_read_b64 v[148:149], v17 offset:61184
    ds_read_b64 v[150:151], v17 offset:61312
    ds_read_b32 v168, v170
    s_add_u32 s4, s4, 1
    s_waitcnt lgkmcnt(0)
    v_bitop3_b32 v23, v145, v147, v3 bitop3:0x7e
    v_bitop3_b32 v24, v149, v151, v3 bitop3:0x7e
    v_or_b32 v23, v23, v24
    v_cmp_ne_u32 vcc, 0, v23
    s_cbranch_vccz Lstback
    s_cmp_lt_u32 s4, 4
    s_cbranch_scc1 Lstslow1
    buffer_store_dwordx2 v[28:29], v25, s[44:47], s54 offen offset:2048 sc1
Lstslow2:
    buffer_load_dwordx2 v[144:145], v19, s[44:47], s54 offen offset:2048 sc1
    buffer_load_dwordx2 v[146:147], v19, s[44:47], s54 offen offset:2304 sc1
    buffer_load_dwordx2 v[148:149], v19, s[44:47], s54 offen offset:2560 sc1
    buffer_load_dwordx2 v[150:151], v19, s[44:47], s54 offen offset:2816 sc1
    s_add_u32 s59, s59, 1
    s_cmp_gt_u32 s59, 0x100000
    s_cbranch_scc1 Lend
    s_waitcnt vmcnt(0)
    v_bitop3_b32 v23, v145, v147, v3 bitop3:0x7e
    v_bitop3_b32 v24, v149, v151, v3 bitop3:0x7e
    v_or_b32 v23, v23, v24
    v_cmp_ne_u32 vcc, 0, v23
    s_cbranch_vccnz Lstslow2
    s_branch Lstback
LA_retry:
    s_mov_b32 s4, 0
LA_retry2:
    buffer_load_dword v168, v169, s[44:47], s7 offen offset:256 sc1
    s_add_u32 s4, s4, 1
    s_waitcnt vmcnt(0)
    v_cmp_ne_u32 vcc, s6, v168
    s_cbranch_vccz LA_fast
    s_cmp_lt_u32 s4, 16
    s_cbranch_scc1 LA_retry2
    buffer_store_dwordx2 v[28:29], v25, s[44:47], s54 offen offset:2048 sc1
    s_branch LA_slow
Lslow4_2:
    ds_read_b128 v[20:23], v9 offset:0
    s_add_u32 s59, s59, 1
    s_cmp_gt_u32 s59, 0x100000
    s_cbranch_scc1 Lend
    s_waitcnt lgkmcnt(0)
    v_min3_u32 v20, v20, v21, v22
    v_min_u32 v20, v20, v23
    v_cmp_ne_u32 vcc, s53, v20
    s_cbranch_vccnz Lslow4_2
    s_branch Lback_3
Lslow4_4:
    ds_read_b128 v[20:23], v9 offset:16
    s_add_u32 s59, s59, 1
    s_cmp_gt_u32 s59, 0x100000
    s_cbranch_scc1 Lend
    s_waitcnt lgkmcnt(0)
    v_min3_u32 v20, v20, v21, v22
    v_min_u32 v20, v20, v23
    v_cmp_ne_u32 vcc, s53, v20
    s_cbranch_vccnz Lslow4_4
    s_branch Lback_5
Lslow4_6:
    ds_read_b128 v[20:23], v9 offset:32
    s_add_u32 s59, s59, 1
    s_cmp_gt_u32 s59, 0x100000
    s_cbranch_scc1 Lend
    s_waitcnt lgkmcnt(0)
    v_min3_u32 v20, v20, v21, v22
    v_min_u32 v20, v20, v23
    v_cmp_ne_u32 vcc, s53, v20
    s_cbranch_vccnz Lslow4_6
    s_branch Lback_7
Lslow4_8:
    ds_read_b128 v[20:23], v9 offset:48
    s_add_u32 s59, s59, 1
    s_cmp_gt_u32 s59, 0x100000
    s_cbranch_scc1 Lend
    s_waitcnt lgkmcnt(0)
    v_min3_u32 v20, v20, v21, v22
    v_min_u32 v20, v20, v23
    v_cmp_ne_u32 vcc, s53, v20
    s_cbranch_vccnz Lslow4_8
    s_branch Lback_9
Lslowpoll_10:
    buffer_load_dword v22, v23, s[44:47], s54 offen offset:1920 sc1
    s_add_u32 s59, s59, 1
    s_cmp_gt_u32 s59, 0x100000
    s_cbranch_scc1 Lend
    s_waitcnt vmcnt(0)
    v_cmp_ne_u32 vcc, s53, v22
    s_cbranch_vccnz Lslowpoll_10
    s_branch Lback_11
Lslowpoll_12:
    buffer_load_dword v22, v2, s[44:47], s13 offen offset:1024 sc1
    s_add_u32 s59, s59, 1
    s_cmp_gt_u32 s59, 0x100000
    s_cbranch_scc1 Lend
    s_waitcnt vmcnt(0)
    v_cmp_ne_u32 vcc, s53, v22
    s_cbranch_vccnz Lslowpoll_12
    s_branch Lback_13
LB_retry:
    s_mov_b32 s4, 0
LB_retry2:
    buffer_load_dword v251, v248, s[44:47], s7 offen offset:256 sc1
    s_add_u32 s4, s4, 1
    s_waitcnt vmcnt(0)
    v_cmp_ne_u32 vcc, s6, v251
    s_cbranch_vccz LB_fast
    s_cmp_lt_u32 s4, 16
    s_cbranch_scc1 LB_retry2
    s_branch LB_slow
Lslowcnt_16:
    buffer_load_dword v15, v9, s[44:47], s10 offen offset:512 sc1
    s_add_u32 s59, s59, 1
    s_cmp_gt_u32 s59, 0x100000
    s_cbranch_scc1 Lend
    s_waitcnt vmcnt(0)
    s_add_u32 s11, s53, 1
    v_subrev_u32 v20, s11, v15
    v_cmp_le_u32 vcc, 15, v20
    s_cbranch_vccnz Lslowcnt_16
    s_branch Lback_17
Lslowcnt_18:
    buffer_load_dword v10, v9, s[44:47], s10 offen offset:512 sc1
    s_add_u32 s59, s59, 1
    s_cmp_gt_u32 s59, 0x100000
    s_cbranch_scc1 Lend
    s_waitcnt vmcnt(0)
    s_add_u32 s11, s53, 3
    v_subrev_u32 v20, s11, v10
    v_cmp_le_u32 vcc, 13, v20
    s_cbranch_vccnz Lslowcnt_18
    s_branch Lback_19
Lslowcnt_20:
    buffer_load_dword v10, v9, s[44:47], s10 offen offset:512 sc1
    s_add_u32 s59, s59, 1
    s_cmp_gt_u32 s59, 0x100000
    s_cbranch_scc1 Lend
    s_waitcnt vmcnt(0)
    s_add_u32 s11, s53, 5
    v_subrev_u32 v20, s11, v10
    v_cmp_le_u32 vcc, 11, v20
    s_cbranch_vccnz Lslowcnt_20
    s_branch Lback_21
Lslowcnt_22:
    buffer_load_dword v10, v9, s[44:47], s10 offen offset:512 sc1
    s_add_u32 s59, s59, 1
    s_cmp_gt_u32 s59, 0x100000
    s_cbranch_scc1 Lend
    s_waitcnt vmcnt(0)
    s_add_u32 s11, s53, 7
    v_subrev_u32 v20, s11, v10
    v_cmp_le_u32 vcc, 9, v20
    s_cbranch_vccnz Lslowcnt_22
    s_branch Lback_23
Lend:
    s_endpgm
Lhot_end:
LA_slow:
    s_waitcnt vmcnt(0) lgkmcnt(0)
    s_nop 15
    s_nop 1
    .p2align 3
    v_pk_fma_f32 v[96:97], v[92:93], v[144:145], v[96:97] op_sel_hi:[1,0,1]
    v_pk_fma_f32 v[98:99], v[94:95], v[144:145], v[98:99] op_sel_hi:[1,0,1]
    v_pk_fma_f32 v[100:101], v[92:93], v[146:147], v[100:101] op_sel_hi:[1,0,1]
    v_pk_fma_f32 v[102:103], v[94:95], v[146:147], v[102:103] op_sel_hi:[1,0,1]
    v_pk_fma_f32 v[104:105], v[92:93], v[148:149], v[104:105] op_sel_hi:[1,0,1]
    v_pk_fma_f32 v[106:107], v[94:95], v[148:149], v[106:107] op_sel_hi:[1,0,1]
    v_pk_fma_f32 v[108:109], v[92:93], v[150:151], v[108:109] op_sel_hi:[1,0,1]
    v_pk_fma_f32 v[110:111], v[94:95], v[150:151], v[110:111] op_sel_hi:[1,0,1]
    v_pk_mul_f32 v[96:97], v[96:97], v[144:145] op_sel:[0,1] op_sel_hi:[1,1]
    v_pk_mul_f32 v[98:99], v[98:99], v[144:145] op_sel:[0,1] op_sel_hi:[1,1]
    v_pk_mul_f32 v[100:101], v[100:101], v[146:147] op_sel:[0,1] op_sel_hi:[1,1]
    v_pk_mul_f32 v[102:103], v[102:103], v[146:147] op_sel:[0,1] op_sel_hi:[1,1]
    v_pk_mul_f32 v[104:105], v[104:105], v[148:149] op_sel:[0,1] op_sel_hi:[1,1]
    v_pk_mul_f32 v[106:107], v[106:107], v[148:149] op_sel:[0,1] op_sel_hi:[1,1]
    v_pk_mul_f32 v[108:109], v[108:109], v[150:151] op_sel:[0,1] op_sel_hi:[1,1]
    v_pk_mul_f32 v[110:111], v[110:111], v[150:151] op_sel:[0,1] op_sel_hi:[1,1]
    v_pk_mul_f32 v[112:113], v[96:97], v[96:97]
    v_pk_mul_f32 v[114:115], v[98:99], v[98:99]
    v_pk_mul_f32 v[116:117], v[100:101], v[100:101]
    v_pk_mul_f32 v[118:119], v[102:103], v[102:103]
    v_pk_mul_f32 v[120:121], v[104:105], v[104:105]
    v_pk_mul_f32 v[122:123], v[106:107], v[106:107]
    v_pk_mul_f32 v[124:125], v[108:109], v[108:109]
    v_pk_mul_f32 v[126:127], v[110:111], v[110:111]
    v_pk_fma_f32 v[112:113], v[112:113], v[20:21], v[20:21] op_sel:[0,1,0] op_sel_hi:[1,1,0]
    v_pk_fma_f32 v[114:115], v[114:115], v[20:21], v[20:21] op_sel:[0,1,0] op_sel_hi:[1,1,0]
    v_pk_fma_f32 v[116:117], v[116:117], v[20:21], v[20:21] op_sel:[0,1,0] op_sel_hi:[1,1,0]
    v_pk_fma_f32 v[118:119], v[118:119], v[20:21], v[20:21] op_sel:[0,1,0] op_sel_hi:[1,1,0]
    v_pk_fma_f32 v[120:121], v[120:121], v[20:21], v[20:21] op_sel:[0,1,0] op_sel_hi:[1,1,0]
    v_pk_fma_f32 v[122:123], v[122:123], v[20:21], v[20:21] op_sel:[0,1,0] op_sel_hi:[1,1,0]
    v_pk_fma_f32 v[124:125], v[124:125], v[20:21], v[20:21] op_sel:[0,1,0] op_sel_hi:[1,1,0]
    v_pk_fma_f32 v[126:127], v[126:127], v[20:21], v[20:21] op_sel:[0,1,0] op_sel_hi:[1,1,0]
    v_pk_mul_f32 v[112:113], v[112:113], v[96:97]
    v_pk_mul_f32 v[114:115], v[114:115], v[98:99]
    v_pk_mul_f32 v[116:117], v[116:117], v[100:101]
    v_pk_mul_f32 v[118:119], v[118:119], v[102:103]
    v_pk_mul_f32 v[120:121], v[120:121], v[104:105]
    v_pk_mul_f32 v[122:123], v[122:123], v[106:107]
    v_pk_mul_f32 v[124:125], v[124:125], v[108:109]
    v_pk_mul_f32 v[126:127], v[126:127], v[110:111]
    v_exp_f32 v112, v112
    v_exp_f32 v113, v113
    v_exp_f32 v114, v114
    v_exp_f32 v115, v115
    v_exp_f32 v116, v116
    v_exp_f32 v117, v117
    v_exp_f32 v118, v118
    v_exp_f32 v119, v119
    v_exp_f32 v120, v120
    v_exp_f32 v121, v121
    v_exp_f32 v122, v122
    v_exp_f32 v123, v123
    v_exp_f32 v124, v124
    v_exp_f32 v125, v125
    v_exp_f32 v126, v126
    v_exp_f32 v127, v127
    v_pk_add_f32 v[112:113], v[112:113], v[22:23] op_sel_hi:[1,0]
    v_pk_add_f32 v[114:115], v[114:115], v[22:23] op_sel_hi:[1,0]
    v_pk_add_f32 v[116:117], v[116:117], v[22:23] op_sel_hi:[1,0]
    v_pk_add_f32 v[118:119], v[118:119], v[22:23] op_sel_hi:[1,0]
    v_pk_add_f32 v[120:121], v[120:121], v[22:23] op_sel_hi:[1,0]
    v_pk_add_f32 v[122:123], v[122:123], v[22:23] op_sel_hi:[1,0]
    v_pk_add_f32 v[124:125], v[124:125], v[22:23] op_sel_hi:[1,0]
    v_pk_add_f32 v[126:127], v[126:127], v[22:23] op_sel_hi:[1,0]
    v_rcp_f32 v112, v112
    v_rcp_f32 v113, v113
    v_rcp_f32 v114, v114
    v_rcp_f32 v115, v115
    v_rcp_f32 v116, v116
    v_rcp_f32 v117, v117
    v_rcp_f32 v118, v118
    v_rcp_f32 v119, v119
    v_rcp_f32 v120, v120
    v_rcp_f32 v121, v121
    v_rcp_f32 v122, v122
    v_rcp_f32 v123, v123
    v_rcp_f32 v124, v124
    v_rcp_f32 v125, v125
    v_rcp_f32 v126, v126
    v_rcp_f32 v127, v127
    v_pk_mul_f32 v[96:97], v[96:97], v[112:113]
    v_pk_mul_f32 v[98:99], v[98:99], v[114:115]
    v_pk_mul_f32 v[100:101], v[100:101], v[116:117]
    v_pk_mul_f32 v[102:103], v[102:103], v[118:119]
    v_pk_mul_f32 v[104:105], v[104:105], v[120:121]
    v_pk_mul_f32 v[106:107], v[106:107], v[122:123]
    v_pk_mul_f32 v[108:109], v[108:109], v[124:125]
    v_pk_mul_f32 v[110:111], v[110:111], v[126:127]
    v_cvt_pk_bf16_f32 v160, v96, v97
    v_cvt_pk_bf16_f32 v162, v100, v101
    v_cvt_pk_bf16_f32 v161, v98, v99
    v_cvt_pk_bf16_f32 v163, v102, v103
    v_cvt_pk_bf16_f32 v164, v104, v105
    v_cvt_pk_bf16_f32 v166, v108, v109
    v_cvt_pk_bf16_f32 v165, v106, v107
    v_cvt_pk_bf16_f32 v167, v110, v111
    v_permlane32_swap_b32 v160, v162
    v_permlane32_swap_b32 v161, v163
    buffer_store_dwordx4 v[160:163], v18, s[40:43], s8 offen sc1
    v_permlane32_swap_b32 v164, v166
    v_permlane32_swap_b32 v165, v167
    buffer_store_dwordx4 v[164:167], v18, s[40:43], s10 offen sc1
    s_barrier
    s_waitcnt vmcnt(0)
    buffer_store_dword v3, v8, s[44:47], s9 offen offset:0 sc1
    s_barrier
    ds_read_b64_tr_b16 v[144:145], v13 offset:5120
    ds_read_b64_tr_b16 v[146:147], v13 offset:9216
    ds_read_b64_tr_b16 v[148:149], v13 offset:7168
    ds_read_b64_tr_b16 v[150:151], v13 offset:11264
    ds_read_b64_tr_b16 v[152:153], v13 offset:13312
    ds_read_b64_tr_b16 v[154:155], v13 offset:17408
    ds_read_b64_tr_b16 v[156:157], v13 offset:15360
    ds_read_b64_tr_b16 v[158:159], v13 offset:19456
    ds_read_b64_tr_b16 v[160:161], v13 offset:21504
    ds_read_b64_tr_b16 v[162:163], v13 offset:25600
    ds_read_b64_tr_b16 v[164:165], v13 offset:23552
    ds_read_b64_tr_b16 v[166:167], v13 offset:27648
    ds_read_b64_tr_b16 v[168:169], v13 offset:29696
    ds_read_b64_tr_b16 v[170:171], v13 offset:33792
    ds_read_b64_tr_b16 v[172:173], v13 offset:31744
    ds_read_b64_tr_b16 v[174:175], v13 offset:35840
    ds_read_b64_tr_b16 v[176:177], v13 offset:37888
    ds_read_b64_tr_b16 v[178:179], v13 offset:41984
    ds_read_b64_tr_b16 v[180:181], v13 offset:39936
    ds_read_b64_tr_b16 v[182:183], v13 offset:44032
    ds_read_b64_tr_b16 v[184:185], v12 offset:0
    ds_read_b64_tr_b16 v[186:187], v12 offset:4096
    ds_read_b64_tr_b16 v[188:189], v12 offset:2048
    ds_read_b64_tr_b16 v[190:191], v12 offset:6144
    v_xor_b32 v20, v5, v0
    v_and_b32 v20, 1, v20
    v_add_u32 v20, -1, v20
    v_and_b32 v104, 0x3f803f80, v20
    v_and_b32 v105, 0x3f803f80, v20
    v_and_b32 v106, 0x3f803f80, v20
    v_and_b32 v107, 0x3f803f80, v20
    s_waitcnt lgkmcnt(14)
    s_nop 0
    v_mfma_f32_16x16x32_bf16 v[40:43], v[104:107], v[144:147], 0
    v_mfma_f32_16x16x32_bf16 v[40:43], v[104:107], v[148:151], v[40:43]
    v_mfma_f32_16x16x32_bf16 v[40:43], v[104:107], v[152:155], v[40:43]
    v_mfma_f32_16x16x32_bf16 v[40:43], v[104:107], v[156:159], v[40:43]
    v_mfma_f32_16x16x32_bf16 v[40:43], v[104:107], v[160:163], v[40:43]
    s_waitcnt lgkmcnt(12)
    v_mfma_f32_16x16x32_bf16 v[40:43], v[104:107], v[164:167], v[40:43]
    s_waitcnt lgkmcnt(10)
    v_mfma_f32_16x16x32_bf16 v[40:43], v[104:107], v[168:171], v[40:43]
    s_waitcnt lgkmcnt(8)
    v_mfma_f32_16x16x32_bf16 v[40:43], v[104:107], v[172:175], v[40:43]
    s_waitcnt lgkmcnt(6)
    v_mfma_f32_16x16x32_bf16 v[40:43], v[104:107], v[176:179], v[40:43]
    s_waitcnt lgkmcnt(4)
    v_mfma_f32_16x16x32_bf16 v[40:43], v[104:107], v[180:183], v[40:43]
    s_waitcnt lgkmcnt(2)
    v_mfma_f32_16x16x32_bf16 v[40:43], v[104:107], v[184:187], v[40:43]
    s_waitcnt lgkmcnt(0)
    v_mfma_f32_16x16x32_bf16 v[40:43], v[104:107], v[188:191], v[40:43]
    v_add_u32 v10, 62464, v1
    v_lshlrev_b32 v14, 3, v0
    v_add_u32 v15, 159744, v14
    v_add_u32 v14, 57344, v14
    v_lshrrev_b32 v20, 2, v7
    v_and_b32 v21, 1, v7
    v_lshl_add_u32 v20, v20, 1, v21
    v_lshlrev_b32 v20, 10, v20
    v_and_b32 v21, 2, v7
    v_lshl_add_u32 v20, v21, 2, v20
    v_lshl_add_u32 v20, v6, 4, v20
    s_lshl_b32 s4, s48, 7
    s_lshl_b32 s5, s49, 12
    s_add_u32 s4, s4, s5
    v_add_u32 v16, s4, v20
    s_mul_i32 s8, s48, 14336
    s_lshl_b32 s5, s49, 10
    s_add_u32 s8, s8, s5
    s_add_u32 s8, s8, s54
    s_mul_i32 s5, s50, 57344
    s_sub_u32 s5, s5, s54
    s_add_u32 s14, s8, s5
    s_add_u32 s15, s8, 122880
    s_add_u32 s16, s8, 180224
    s_add_u32 s18, s8, 237568
    s_lshl_b32 s9, s48, 7
    s_lshl_b32 s5, s49, 2
    s_add_u32 s9, s9, s5
    s_add_u32 s9, s9, s54
    s_lshl2_add_u32 s4, s49, s48
    s_lshl_b32 s4, s4, 5
    s_add_u32 s12, s4, s54
    s_add_u32 s13, s4, s55
    s_lshl3_add_u32 s7, s51, s48
    s_mul_i32 s7, s7, 56
    s_add_u32 s7, s7, s49
    s_lshl_b32 s7, s7, 7
    s_lshl3_add_u32 s17, s50, s48
    s_mul_i32 s17, s17, 56
    s_add_u32 s17, s17, s49
    s_lshl_b32 s17, s17, 7
    s_barrier
    ds_read_b64_tr_b16 v[192:193], v12 offset:8192
    ds_read_b64_tr_b16 v[194:195], v12 offset:12288
    ds_read_b64_tr_b16 v[196:197], v12 offset:10240
    ds_read_b64_tr_b16 v[198:199], v12 offset:14336
    ds_read_b64_tr_b16 v[200:201], v12 offset:16384
    ds_read_b64_tr_b16 v[202:203], v12 offset:20480
    ds_read_b64_tr_b16 v[204:205], v12 offset:18432
    ds_read_b64_tr_b16 v[206:207], v12 offset:22528
    ds_read_b64_tr_b16 v[208:209], v12 offset:24576
    ds_read_b64_tr_b16 v[210:211], v12 offset:28672
    ds_read_b64_tr_b16 v[212:213], v12 offset:26624
    ds_read_b64_tr_b16 v[214:215], v12 offset:30720
    ds_read_b64_tr_b16 v[216:217], v12 offset:32768
    ds_read_b64_tr_b16 v[218:219], v12 offset:36864
    ds_read_b64_tr_b16 v[220:221], v12 offset:34816
    ds_read_b64_tr_b16 v[222:223], v12 offset:38912
    ds_read_b64_tr_b16 v[224:225], v12 offset:40960
    ds_read_b64_tr_b16 v[226:227], v12 offset:45056
    ds_read_b64_tr_b16 v[228:229], v12 offset:43008
    ds_read_b64_tr_b16 v[230:231], v12 offset:47104
    ds_read_b64_tr_b16 v[232:233], v12 offset:49152
    ds_read_b64_tr_b16 v[234:235], v12 offset:53248
    ds_read_b64_tr_b16 v[236:237], v12 offset:51200
    ds_read_b64_tr_b16 v[238:239], v12 offset:55296
    ds_read_b64_tr_b16 v[240:241], v13 offset:46080
    ds_read_b64_tr_b16 v[242:243], v13 offset:50176
    ds_read_b64_tr_b16 v[244:245], v13 offset:48128
    ds_read_b64_tr_b16 v[246:247], v13 offset:52224
    ds_read_b64_tr_b16 v[248:249], v13 offset:54272
    ds_read_b64_tr_b16 v[250:251], v13 offset:58368
    ds_read_b64_tr_b16 v[252:253], v13 offset:56320
    ds_read_b64_tr_b16 v[254:255], v13 offset:60416
    s_waitcnt lgkmcnt(14)
    v_mfma_f32_16x16x32_bf16 v[40:43], v[104:107], v[192:195], v[40:43]
    v_mfma_f32_16x16x32_bf16 v[40:43], v[104:107], v[196:199], v[40:43]
    v_mfma_f32_16x16x32_bf16 v[40:43], v[104:107], v[200:203], v[40:43]
    v_mfma_f32_16x16x32_bf16 v[40:43], v[104:107], v[204:207], v[40:43]
    v_mfma_f32_16x16x32_bf16 v[40:43], v[104:107], v[208:211], v[40:43]
    v_mfma_f32_16x16x32_bf16 v[40:43], v[104:107], v[212:215], v[40:43]
    v_mfma_f32_16x16x32_bf16 v[40:43], v[104:107], v[216:219], v[40:43]
    v_mfma_f32_16x16x32_bf16 v[40:43], v[104:107], v[220:223], v[40:43]
    v_mfma_f32_16x16x32_bf16 v[40:43], v[104:107], v[224:227], v[40:43]
    s_waitcnt lgkmcnt(12)
    v_mfma_f32_16x16x32_bf16 v[40:43], v[104:107], v[228:231], v[40:43]
    s_waitcnt lgkmcnt(10)
    v_mfma_f32_16x16x32_bf16 v[40:43], v[104:107], v[232:235], v[40:43]
    s_waitcnt lgkmcnt(8)
    v_mfma_f32_16x16x32_bf16 v[40:43], v[104:107], v[236:239], v[40:43]
    s_waitcnt lgkmcnt(6)
    v_mfma_f32_16x16x32_bf16 v[40:43], v[104:107], v[240:243], v[40:43]
    s_waitcnt lgkmcnt(4)
    v_mfma_f32_16x16x32_bf16 v[40:43], v[104:107], v[244:247], v[40:43]
    s_waitcnt lgkmcnt(2)
    v_mfma_f32_16x16x32_bf16 v[40:43], v[104:107], v[248:251], v[40:43]
    s_waitcnt lgkmcnt(0)
    v_mfma_f32_16x16x32_bf16 v[40:43], v[104:107], v[252:255], v[40:43]
    v_cmp_eq_u32 vcc, 1, v5
    s_nop 6
    v_cndmask_b32 v40, v40, v41, vcc
    v_cvt_pk_bf16_f32 v20, v40, v40
    v_and_b32 v21, 0xffff0000, v20
    v_sub_f32 v21, v40, v21
    v_cmp_gt_u32 vcc, 32, v0
    v_cvt_pk_bf16_f32 v20, v40, v21
    s_nop 0
    v_cndmask_b32 v18, 0, v20, vcc
    v_mov_b32 v19, v18
    s_setprio 2
    s_barrier
    ds_read_b128 v[56:59], v10 offset:0
    ds_read_b128 v[60:63], v10 offset:1024
    ds_read_b128 v[64:67], v10 offset:2048
    ds_read_b128 v[68:71], v10 offset:3072
    ds_read_b128 v[72:75], v10 offset:4096
    ds_read_b128 v[76:79], v10 offset:5120
    ds_read_b128 v[80:83], v10 offset:6144
    ds_read_b128 v[84:87], v10 offset:7168
    v_add_u32 v11, 7168, v1
    s_waitcnt lgkmcnt(7)
    v_mfma_f32_32x32x16_bf16 v[24:39], v[144:147], v[56:59], 0
    ds_read_b128 v[88:91], v10 offset:8192
    ds_read_b64 v[104:105], v14 offset:0
    ds_read_b64 v[106:107], v14 offset:512
    ds_read_b64 v[108:109], v14 offset:1024
    ds_read_b64 v[110:111], v14 offset:1536
    s_waitcnt lgkmcnt(11)
    v_mfma_f32_32x32x16_bf16 v[24:39], v[148:151], v[60:63], v[24:39]
    ds_read_b128 v[92:95], v10 offset:9216
    ds_read_b64 v[40:41], v14 offset:4096
    ds_read_b64 v[42:43], v14 offset:4608
    ds_read_b64 v[44:45], v15 offset:1024
    ds_read_b64 v[46:47], v15 offset:1536
    s_waitcnt lgkmcnt(14)
    v_mfma_f32_32x32x16_bf16 v[24:39], v[152:155], v[64:67], v[24:39]
    ds_read_b128 v[96:99], v10 offset:10240
    ds_read_b64 v[112:113], v14 offset:2048
    ds_read_b64 v[114:115], v14 offset:2560
    ds_read_b64 v[116:117], v14 offset:3072
    v_mfma_f32_32x32x16_bf16 v[24:39], v[156:159], v[68:71], v[24:39]
    ds_read_b128 v[56:59], v10 offset:11264
    ds_read_b64 v[48:49], v15 offset:2048
    ds_read_b64 v[50:51], v15 offset:2560
    ds_read_b64 v[52:53], v15 offset:3072
    s_waitcnt lgkmcnt(14)
    v_mfma_f32_32x32x16_bf16 v[24:39], v[160:163], v[72:75], v[24:39]
    ds_read_b128 v[60:63], v10 offset:12288
    v_mfma_f32_32x32x16_bf16 v[24:39], v[164:167], v[76:79], v[24:39]
    ds_read_b128 v[20:23], v9 offset:0
    ds_read_b128 v[64:67], v10 offset:13312
    v_mfma_f32_32x32x16_bf16 v[24:39], v[168:171], v[80:83], v[24:39]
    ds_read_b128 v[68:71], v10 offset:14336
    v_add_f32 v104, v104, v106
    s_waitcnt lgkmcnt(14)
    v_add_f32 v40, v40, v42
    v_add_f32 v105, v105, v107
    v_add_f32 v41, v41, v43
    v_add_f32 v104, v104, v108
    v_mfma_f32_32x32x16_bf16 v[24:39], v[172:175], v[84:87], v[24:39]
    ds_read_b128 v[72:75], v10 offset:15360
    s_waitcnt lgkmcnt(14)
    v_add_f32 v40, v40, v44
    v_add_f32 v105, v105, v109
    v_add_f32 v41, v41, v45
    v_add_f32 v104, v104, v110
    s_waitcnt lgkmcnt(13)
    v_add_f32 v40, v40, v46
    s_waitcnt lgkmcnt(8)
    v_mfma_f32_32x32x16_bf16 v[24:39], v[176:179], v[88:91], v[24:39]
    s_waitcnt lgkmcnt(3)
    v_min3_u32 v20, v20, v21, v22
    v_min_u32 v20, v20, v23
    v_cmp_ne_u32 vcc, s53, v20
    s_cbranch_vccnz Lslow4_25
Lback_26:
    ds_read_b128 v[76:79], v10 offset:16384
    v_mfma_f32_32x32x16_bf16 v[24:39], v[180:183], v[92:95], v[24:39]
    ds_read_b128 v[80:83], v10 offset:17408
    v_add_f32 v105, v105, v111
    v_add_f32 v41, v41, v47
    v_add_f32 v104, v104, v112
    v_add_f32 v40, v40, v48
    v_add_f32 v105, v105, v113
    v_mfma_f32_32x32x16_bf16 v[24:39], v[184:187], v[96:99], v[24:39]
    ds_read_b128 v[84:87], v10 offset:18432
    v_add_f32 v41, v41, v49
    v_add_f32 v104, v104, v114
    v_add_f32 v40, v40, v50
    v_add_f32 v105, v105, v115
    v_add_f32 v41, v41, v51
    v_mfma_f32_32x32x16_bf16 v[24:39], v[188:191], v[56:59], v[24:39]
    ds_read_b128 v[88:91], v10 offset:19456
    v_add_f32 v104, v104, v116
    v_add_f32 v40, v40, v52
    v_add_f32 v105, v105, v117
    v_add_f32 v41, v41, v53
    s_waitcnt lgkmcnt(4)
    v_mfma_f32_32x32x16_bf16 v[24:39], v[192:195], v[60:63], v[24:39]
    ds_read_b128 v[92:95], v10 offset:20480
    v_mul_f32 v104, 0xbb124925, v104
    v_mul_f32 v40, 0xbb124925, v40
    v_mul_f32 v105, 0x3b124925, v105
    v_mul_f32 v41, 0x3b124925, v41
    v_mfma_f32_32x32x16_bf16 v[24:39], v[196:199], v[64:67], v[24:39]
    ds_read_b128 v[96:99], v10 offset:21504
    v_cvt_pk_bf16_f32 v124, v104, v104
    v_cvt_pk_bf16_f32 v128, v40, v40
    v_fma_f32 v105, -v104, v104, v105
    v_fma_f32 v41, -v40, v40, v41
    v_max_f32 v105, 0, v105
    v_mfma_f32_32x32x16_bf16 v[24:39], v[200:203], v[68:71], v[24:39]
    ds_read_b128 v[56:59], v10 offset:22528
    v_max_f32 v41, 0, v41
    v_cvt_pk_bf16_f32 v105, v105, v105
    v_cvt_pk_bf16_f32 v41, v41, v41
    v_and_b32 v105, 0xffff0000, v105
    v_and_b32 v41, 0xffff0000, v41
    v_mfma_f32_32x32x16_bf16 v[24:39], v[204:207], v[72:75], v[24:39]
    ds_read_b128 v[60:63], v10 offset:23552
    v_add_f32 v105, 0x3727c5ac, v105
    v_add_f32 v41, 0x3727c5ac, v41
    v_cvt_pk_bf16_f32 v105, v105, v105
    v_cvt_pk_bf16_f32 v41, v41, v41
    v_and_b32 v105, 0xffff0000, v105
    s_waitcnt lgkmcnt(4)
    v_mfma_f32_32x32x16_bf16 v[24:39], v[208:211], v[76:79], v[24:39]
    ds_read_b128 v[64:67], v10 offset:24576
    v_and_b32 v41, 0xffff0000, v41
    v_sqrt_f32 v134, v105
    v_mfma_f32_32x32x16_bf16 v[24:39], v[212:215], v[80:83], v[24:39]
    ds_read_b128 v[20:23], v9 offset:16
    ds_read_b128 v[68:71], v10 offset:25600
    v_sqrt_f32 v140, v41
    v_mov_b32 v125, 0
    v_mov_b32 v129, 0
    v_mov_b32 v127, 0
    v_mfma_f32_32x32x16_bf16 v[24:39], v[216:219], v[84:87], v[24:39]
    ds_read_b128 v[72:75], v10 offset:26624
    v_mov_b32 v131, 0
    v_cvt_pk_bf16_f32 v134, v134, v134
    v_cvt_pk_bf16_f32 v140, v140, v140
    v_and_b32 v134, 0xffff0000, v134
    v_and_b32 v140, 0xffff0000, v140
    v_mfma_f32_32x32x16_bf16 v[24:39], v[220:223], v[88:91], v[24:39]
    ds_read_b128 v[76:79], v10 offset:27648
    v_rcp_f32 v106, v134
    v_rcp_f32 v42, v140
    v_mov_b32 v126, v124
    s_waitcnt lgkmcnt(5)
    v_mfma_f32_32x32x16_bf16 v[24:39], v[224:227], v[92:95], v[24:39]
    s_waitcnt lgkmcnt(3)
    v_min3_u32 v20, v20, v21, v22
    v_min_u32 v20, v20, v23
    v_cmp_ne_u32 vcc, s53, v20
    s_cbranch_vccnz Lslow4_27
Lback_28:
    ds_read_b128 v[80:83], v10 offset:28672
    v_mfma_f32_32x32x16_bf16 v[24:39], v[228:231], v[96:99], v[24:39]
    ds_read_b128 v[84:87], v10 offset:29696
    v_mov_b32 v130, v128
    v_mul_f32 v132, 0xc0135761, v106
    v_mul_f32 v138, 0xc0135761, v42
    v_mul_f32 v107, v106, v106
    v_mfma_f32_32x32x16_bf16 v[24:39], v[232:235], v[56:59], v[24:39]
    ds_read_b128 v[88:91], v10 offset:30720
    v_mul_f32 v43, v42, v42
    v_mul_f32 v107, 0x3d372713, v107
    v_mul_f32 v43, 0x3d372713, v43
    v_mov_b32 v135, v132
    v_mov_b32 v141, v138
    v_mfma_f32_32x32x16_bf16 v[24:39], v[236:239], v[60:63], v[24:39]
    ds_read_b128 v[92:95], v10 offset:31744
    v_mov_b32 v137, v134
    v_mov_b32 v143, v140
    v_mul_f32 v133, v107, v132
    v_mul_f32 v139, v43, v138
    v_permlane32_swap_b32 v124, v126
    s_waitcnt lgkmcnt(4)
    v_mfma_f32_32x32x16_bf16 v[24:39], v[240:243], v[64:67], v[24:39]
    ds_read_b128 v[96:99], v10 offset:32768
    v_permlane32_swap_b32 v128, v130
    v_mov_b32 v136, v133
    v_mov_b32 v142, v139
    v_permlane32_swap_b32 v132, v135
    v_mfma_f32_32x32x16_bf16 v[24:39], v[244:247], v[68:71], v[24:39]
    ds_read_b128 v[56:59], v10 offset:33792
    v_permlane32_swap_b32 v138, v141
    v_permlane32_swap_b32 v134, v137
    v_permlane32_swap_b32 v140, v143
    v_permlane32_swap_b32 v133, v136
    v_permlane32_swap_b32 v139, v142
    v_mfma_f32_32x32x16_bf16 v[24:39], v[248:251], v[72:75], v[24:39]
    ds_read_b128 v[60:63], v10 offset:34816
    v_mfma_f32_32x32x8_bf16 v[24:39], v[18:19], v[124:125], v[24:39]
    v_mfma_f32_32x32x16_bf16 v[24:39], v[252:255], v[76:79], v[24:39]
    ds_read_b128 v[64:67], v10 offset:35840
    s_waitcnt lgkmcnt(4)
    v_mfma_f32_32x32x16_bf16 v[40:55], v[144:147], v[80:83], 0
    ds_read_b128 v[68:71], v10 offset:36864
    v_mfma_f32_32x32x16_bf16 v[40:55], v[148:151], v[84:87], v[40:55]
    ds_read_b128 v[72:75], v10 offset:37888
    v_mfma_f32_32x32x16_bf16 v[40:55], v[152:155], v[88:91], v[40:55]
    ds_read_b128 v[76:79], v10 offset:38912
    s_nop 3
    v_mul_f32 v104, v24, v24
    v_mul_f32 v105, v25, v25
    v_mul_f32 v106, v26, v26
    v_mul_f32 v107, v27, v27
    v_mul_f32 v108, v28, v28
    v_mul_f32 v109, v29, v29
    v_mfma_f32_32x32x8_bf16 v[40:55], v[18:19], v[126:127], v[40:55]
    v_mul_f32 v110, v30, v30
    v_mul_f32 v111, v31, v31
    v_fma_f32 v104, v104, v133, v132
    v_fma_f32 v105, v105, v133, v132
    v_fma_f32 v106, v106, v133, v132
    v_fma_f32 v107, v107, v133, v132
    v_fma_f32 v108, v108, v133, v132
    v_mfma_f32_32x32x16_bf16 v[40:55], v[156:159], v[92:95], v[40:55]
    ds_read_b128 v[80:83], v10 offset:39936
    v_fma_f32 v109, v109, v133, v132
    v_fma_f32 v110, v110, v133, v132
    v_fma_f32 v111, v111, v133, v132
    v_mul_f32 v104, v104, v24
    v_mul_f32 v105, v105, v25
    v_mul_f32 v106, v106, v26
    s_waitcnt lgkmcnt(4)
    v_mfma_f32_32x32x16_bf16 v[40:55], v[160:163], v[96:99], v[40:55]
    ds_read_b128 v[84:87], v10 offset:40960
    v_mul_f32 v107, v107, v27
    v_mul_f32 v108, v108, v28
    v_mul_f32 v109, v109, v29
    v_mul_f32 v110, v110, v30
    v_mul_f32 v111, v111, v31
    v_mfma_f32_32x32x16_bf16 v[40:55], v[164:167], v[56:59], v[40:55]
    ds_read_b128 v[88:91], v10 offset:41984
    v_exp_f32 v104, v104
    v_exp_f32 v105, v105
    v_exp_f32 v106, v106
    v_mfma_f32_32x32x16_bf16 v[40:55], v[168:171], v[60:63], v[40:55]
    ds_read_b128 v[92:95], v10 offset:43008
    v_exp_f32 v107, v107
    v_exp_f32 v108, v108
    v_exp_f32 v109, v109
    v_mfma_f32_32x32x16_bf16 v[40:55], v[172:175], v[64:67], v[40:55]
    ds_read_b128 v[96:99], v10 offset:44032
    v_exp_f32 v110, v110
    v_exp_f32 v111, v111
    v_fma_f32 v104, v104, v134, v134
    v_fma_f32 v105, v105, v134, v134
    v_fma_f32 v106, v106, v134, v134
    s_waitcnt lgkmcnt(4)
    v_mfma_f32_32x32x16_bf16 v[40:55], v[176:179], v[68:71], v[40:55]
    ds_read_b128 v[56:59], v10 offset:45056
    v_fma_f32 v107, v107, v134, v134
    v_fma_f32 v108, v108, v134, v134
    v_fma_f32 v109, v109, v134, v134
    v_fma_f32 v110, v110, v134, v134
    v_fma_f32 v111, v111, v134, v134
    v_mfma_f32_32x32x16_bf16 v[40:55], v[180:183], v[72:75], v[40:55]
    ds_read_b128 v[60:63], v10 offset:46080
    v_rcp_f32 v104, v104
    v_rcp_f32 v105, v105
    v_rcp_f32 v106, v106
    v_mfma_f32_32x32x16_bf16 v[40:55], v[184:187], v[76:79], v[40:55]
    ds_read_b128 v[64:67], v10 offset:47104
    v_rcp_f32 v107, v107
    v_rcp_f32 v108, v108
    v_rcp_f32 v109, v109
    v_mfma_f32_32x32x16_bf16 v[40:55], v[188:191], v[80:83], v[40:55]
    ds_read_b128 v[68:71], v10 offset:48128
    v_rcp_f32 v110, v110
    v_rcp_f32 v111, v111
    v_mul_f32 v104, v104, v24
    v_mul_f32 v105, v105, v25
    s_waitcnt lgkmcnt(4)
    v_mfma_f32_32x32x16_bf16 v[40:55], v[192:195], v[84:87], v[40:55]
    ds_read_b128 v[72:75], v10 offset:49152
    v_mul_f32 v106, v106, v26
    v_mul_f32 v107, v107, v27
    v_mul_f32 v108, v108, v28
    v_mul_f32 v109, v109, v29
    v_mul_f32 v110, v110, v30
    v_mfma_f32_32x32x16_bf16 v[40:55], v[196:199], v[88:91], v[40:55]
    ds_read_b128 v[76:79], v10 offset:50176
    v_mul_f32 v111, v111, v31
    v_cvt_pk_bf16_f32 v100, v104, v105
    v_cvt_pk_bf16_f32 v101, v106, v107
    v_cvt_pk_bf16_f32 v102, v108, v109
    v_cvt_pk_bf16_f32 v103, v110, v111
    v_mul_f32 v104, v32, v32
    v_mfma_f32_32x32x16_bf16 v[40:55], v[200:203], v[92:95], v[40:55]
    ds_read_b128 v[80:83], v10 offset:51200
    v_mul_f32 v105, v33, v33
    v_mul_f32 v106, v34, v34
    v_mul_f32 v107, v35, v35
    v_mul_f32 v108, v36, v36
    v_mul_f32 v109, v37, v37
    v_mul_f32 v110, v38, v38
    v_mfma_f32_32x32x16_bf16 v[40:55], v[204:207], v[96:99], v[40:55]
    ds_read_b128 v[84:87], v10 offset:52224
    v_mul_f32 v111, v39, v39
    v_fma_f32 v104, v104, v133, v132
    v_fma_f32 v105, v105, v133, v132
    v_fma_f32 v106, v106, v133, v132
    v_fma_f32 v107, v107, v133, v132
    v_fma_f32 v108, v108, v133, v132
    s_waitcnt lgkmcnt(4)
    v_mfma_f32_32x32x16_bf16 v[40:55], v[208:211], v[56:59], v[40:55]
    ds_read_b128 v[88:91], v10 offset:53248
    v_fma_f32 v109, v109, v133, v132
    v_fma_f32 v110, v110, v133, v132
    v_fma_f32 v111, v111, v133, v132
    v_mul_f32 v104, v104, v32
    v_mul_f32 v105, v105, v33
    v_mfma_f32_32x32x16_bf16 v[40:55], v[212:215], v[60:63], v[40:55]
    ds_read_b128 v[20:23], v9 offset:32
    ds_read_b128 v[92:95], v10 offset:54272
    v_mul_f32 v106, v106, v34
    v_mul_f32 v107, v107, v35
    v_mul_f32 v108, v108, v36
    v_mul_f32 v109, v109, v37
    v_mul_f32 v110, v110, v38
    v_mfma_f32_32x32x16_bf16 v[40:55], v[216:219], v[64:67], v[40:55]
    ds_read_b128 v[96:99], v10 offset:55296
    v_mul_f32 v111, v111, v39
    v_exp_f32 v104, v104
    v_exp_f32 v105, v105
    v_exp_f32 v106, v106
    v_mfma_f32_32x32x16_bf16 v[40:55], v[220:223], v[68:71], v[40:55]
    ds_read_b128 v[56:59], v10 offset:56320
    v_exp_f32 v107, v107
    v_exp_f32 v108, v108
    v_exp_f32 v109, v109
    s_waitcnt lgkmcnt(5)
    v_mfma_f32_32x32x16_bf16 v[40:55], v[224:227], v[72:75], v[40:55]
    s_waitcnt lgkmcnt(3)
    v_min3_u32 v20, v20, v21, v22
    v_min_u32 v20, v20, v23
    v_cmp_ne_u32 vcc, s53, v20
    s_cbranch_vccnz Lslow4_29
Lback_30:
    ds_read_b128 v[60:63], v1 offset:0
    v_mfma_f32_32x32x16_bf16 v[40:55], v[228:231], v[76:79], v[40:55]
    ds_read_b128 v[64:67], v1 offset:1024
    v_exp_f32 v110, v110
    v_exp_f32 v111, v111
    v_fma_f32 v104, v104, v134, v134
    v_fma_f32 v105, v105, v134, v134
    v_fma_f32 v106, v106, v134, v134
    v_mfma_f32_32x32x16_bf16 v[40:55], v[232:235], v[80:83], v[40:55]
    ds_read_b128 v[68:71], v1 offset:2048
    v_fma_f32 v107, v107, v134, v134
    v_fma_f32 v108, v108, v134, v134
    v_fma_f32 v109, v109, v134, v134
    v_fma_f32 v110, v110, v134, v134
    v_fma_f32 v111, v111, v134, v134
    v_mfma_f32_32x32x16_bf16 v[40:55], v[236:239], v[84:87], v[40:55]
    ds_read_b128 v[72:75], v1 offset:3072
    v_rcp_f32 v104, v104
    v_rcp_f32 v105, v105
    v_rcp_f32 v106, v106
    s_waitcnt lgkmcnt(4)
    v_mfma_f32_32x32x16_bf16 v[40:55], v[240:243], v[88:91], v[40:55]
    ds_read_b128 v[76:79], v1 offset:4096
    v_rcp_f32 v107, v107
    v_rcp_f32 v108, v108
    v_rcp_f32 v109, v109
    v_mfma_f32_32x32x16_bf16 v[40:55], v[244:247], v[92:95], v[40:55]
    ds_read_b128 v[80:83], v1 offset:5120
    v_rcp_f32 v110, v110
    v_rcp_f32 v111, v111
    v_mul_f32 v104, v104, v32
    v_mul_f32 v105, v105, v33
    v_mfma_f32_32x32x16_bf16 v[40:55], v[248:251], v[96:99], v[40:55]
    ds_read_b128 v[84:87], v1 offset:6144
    v_mul_f32 v106, v106, v34
    v_mul_f32 v107, v107, v35
    v_mul_f32 v108, v108, v36
    v_mul_f32 v109, v109, v37
    v_mul_f32 v110, v110, v38
    v_mul_f32 v111, v111, v39
    v_mfma_f32_32x32x16_bf16 v[40:55], v[252:255], v[56:59], v[40:55]
    ds_read_b128 v[88:91], v1 offset:7168
    v_cvt_pk_bf16_f32 v112, v104, v105
    v_cvt_pk_bf16_f32 v113, v106, v107
    v_cvt_pk_bf16_f32 v114, v108, v109
    v_cvt_pk_bf16_f32 v115, v110, v111
    buffer_store_dwordx4 v[100:103], v1, s[40:43], s14 offen sc1
    buffer_store_dwordx4 v[112:115], v11, s[40:43], s14 offen sc1
    s_waitcnt lgkmcnt(4)
    v_mfma_f32_32x32x16_bf16 v[24:39], v[144:147], v[60:63], 0
    ds_read_b128 v[92:95], v1 offset:8192
    v_mfma_f32_32x32x16_bf16 v[24:39], v[148:151], v[64:67], v[24:39]
    ds_read_b128 v[96:99], v1 offset:9216
    v_mfma_f32_32x32x16_bf16 v[24:39], v[152:155], v[68:71], v[24:39]
    ds_read_b128 v[56:59], v1 offset:10240
    v_mul_f32 v104, v40, v40
    v_mul_f32 v105, v41, v41
    v_mul_f32 v106, v42, v42
    v_mul_f32 v107, v43, v43
    v_mul_f32 v108, v44, v44
    v_mul_f32 v109, v45, v45
    v_mfma_f32_32x32x8_bf16 v[24:39], v[18:19], v[128:129], v[24:39]
    v_mul_f32 v110, v46, v46
    v_mul_f32 v111, v47, v47
    v_fma_f32 v104, v104, v136, v135
    v_fma_f32 v105, v105, v136, v135
    v_fma_f32 v106, v106, v136, v135
    v_fma_f32 v107, v107, v136, v135
    v_fma_f32 v108, v108, v136, v135
    v_fma_f32 v109, v109, v136, v135
    v_mfma_f32_32x32x16_bf16 v[24:39], v[156:159], v[72:75], v[24:39]
    ds_read_b128 v[60:63], v1 offset:11264
    v_fma_f32 v110, v110, v136, v135
    v_fma_f32 v111, v111, v136, v135
    v_mul_f32 v104, v104, v40
    v_mul_f32 v105, v105, v41
    v_mul_f32 v106, v106, v42
    v_mul_f32 v107, v107, v43
    s_waitcnt lgkmcnt(4)
    v_mfma_f32_32x32x16_bf16 v[24:39], v[160:163], v[76:79], v[24:39]
    ds_read_b128 v[64:67], v1 offset:12288
    v_mul_f32 v108, v108, v44
    v_mul_f32 v109, v109, v45
    v_mul_f32 v110, v110, v46
    v_mul_f32 v111, v111, v47
    v_exp_f32 v104, v104
    v_mfma_f32_32x32x16_bf16 v[24:39], v[164:167], v[80:83], v[24:39]
    ds_read_b128 v[68:71], v1 offset:13312
    v_exp_f32 v105, v105
    v_exp_f32 v106, v106
    v_exp_f32 v107, v107
    v_mfma_f32_32x32x16_bf16 v[24:39], v[168:171], v[84:87], v[24:39]
    ds_read_b128 v[72:75], v1 offset:14336
    v_exp_f32 v108, v108
    v_exp_f32 v109, v109
    v_exp_f32 v110, v110
    v_mfma_f32_32x32x16_bf16 v[24:39], v[172:175], v[88:91], v[24:39]
    ds_read_b128 v[76:79], v1 offset:15360
    v_exp_f32 v111, v111
    v_fma_f32 v104, v104, v137, v137
    v_fma_f32 v105, v105, v137, v137
    v_fma_f32 v106, v106, v137, v137
    v_fma_f32 v107, v107, v137, v137
    s_waitcnt lgkmcnt(4)
    v_mfma_f32_32x32x16_bf16 v[24:39], v[176:179], v[92:95], v[24:39]
    ds_read_b128 v[80:83], v1 offset:16384
    v_fma_f32 v108, v108, v137, v137
    v_fma_f32 v109, v109, v137, v137
    v_fma_f32 v110, v110, v137, v137
    v_fma_f32 v111, v111, v137, v137
    v_rcp_f32 v104, v104
    v_mfma_f32_32x32x16_bf16 v[24:39], v[180:183], v[96:99], v[24:39]
    ds_read_b128 v[84:87], v1 offset:17408
    v_rcp_f32 v105, v105
    v_rcp_f32 v106, v106
    v_rcp_f32 v107, v107
    v_mfma_f32_32x32x16_bf16 v[24:39], v[184:187], v[56:59], v[24:39]
    ds_read_b128 v[88:91], v1 offset:18432
    ds_read_b64 v[116:117], v16 offset:0
    ds_read_b64 v[118:119], v16 offset:512
    v_rcp_f32 v108, v108
    v_rcp_f32 v109, v109
    v_mfma_f32_32x32x16_bf16 v[24:39], v[188:191], v[60:63], v[24:39]
    ds_read_b128 v[92:95], v1 offset:19456
    v_rcp_f32 v110, v110
    v_rcp_f32 v111, v111
    v_mul_f32 v104, v104, v40
    v_mul_f32 v105, v105, v41
    s_waitcnt lgkmcnt(6)
    v_mfma_f32_32x32x16_bf16 v[24:39], v[192:195], v[64:67], v[24:39]
    ds_read_b128 v[96:99], v1 offset:20480
    v_mul_f32 v106, v106, v42
    v_mul_f32 v107, v107, v43
    v_mul_f32 v108, v108, v44
    v_mul_f32 v109, v109, v45
    v_mul_f32 v110, v110, v46
    v_mfma_f32_32x32x16_bf16 v[24:39], v[196:199], v[68:71], v[24:39]
    ds_read_b128 v[56:59], v1 offset:21504
    v_mul_f32 v111, v111, v47
    v_cvt_pk_bf16_f32 v100, v104, v105
    v_cvt_pk_bf16_f32 v101, v106, v107
    v_cvt_pk_bf16_f32 v102, v108, v109
    v_cvt_pk_bf16_f32 v103, v110, v111
    v_add_u32 v17, 2, v3
    v_mfma_f32_32x32x16_bf16 v[24:39], v[200:203], v[72:75], v[24:39]
    ds_read_b128 v[60:63], v1 offset:22528
    s_waitcnt vmcnt(0)
    buffer_store_dword v17, v8, s[44:47], s9 offen offset:512 sc1
    v_mul_f32 v104, v48, v48
    v_mul_f32 v105, v49, v49
    v_mul_f32 v106, v50, v50
    v_mul_f32 v107, v51, v51
    v_mul_f32 v108, v52, v52
    v_mfma_f32_32x32x16_bf16 v[24:39], v[204:207], v[76:79], v[24:39]
    ds_read_b128 v[64:67], v1 offset:23552
    v_mul_f32 v109, v53, v53
    v_mul_f32 v110, v54, v54
    v_mul_f32 v111, v55, v55
    v_fma_f32 v104, v104, v136, v135
    v_fma_f32 v105, v105, v136, v135
    v_fma_f32 v106, v106, v136, v135
    s_waitcnt lgkmcnt(4)
    v_mfma_f32_32x32x16_bf16 v[24:39], v[208:211], v[80:83], v[24:39]
    ds_read_b128 v[68:71], v1 offset:24576
    v_fma_f32 v107, v107, v136, v135
    v_fma_f32 v108, v108, v136, v135
    v_fma_f32 v109, v109, v136, v135
    v_fma_f32 v110, v110, v136, v135
    v_fma_f32 v111, v111, v136, v135
    v_mfma_f32_32x32x16_bf16 v[24:39], v[212:215], v[84:87], v[24:39]
    ds_read_b128 v[20:23], v9 offset:48
    ds_read_b128 v[72:75], v1 offset:25600
    v_mul_f32 v104, v104, v48
    v_mul_f32 v105, v105, v49
    v_mul_f32 v106, v106, v50
    v_mul_f32 v107, v107, v51
    v_mul_f32 v108, v108, v52
    v_mfma_f32_32x32x16_bf16 v[24:39], v[216:219], v[88:91], v[24:39]
    ds_read_b128 v[76:79], v1 offset:26624
    v_mul_f32 v109, v109, v53
    v_mul_f32 v110, v110, v54
    v_mul_f32 v111, v111, v55
    v_exp_f32 v104, v104
    v_exp_f32 v105, v105
    v_mfma_f32_32x32x16_bf16 v[24:39], v[220:223], v[92:95], v[24:39]
    ds_read_b128 v[80:83], v1 offset:27648
    v_exp_f32 v106, v106
    v_exp_f32 v107, v107
    v_exp_f32 v108, v108
    s_waitcnt lgkmcnt(5)
    v_mfma_f32_32x32x16_bf16 v[24:39], v[224:227], v[96:99], v[24:39]
    s_waitcnt lgkmcnt(3)
    v_min3_u32 v20, v20, v21, v22
    v_min_u32 v20, v20, v23
    v_cmp_ne_u32 vcc, s53, v20
    s_cbranch_vccnz Lslow4_31
Lback_32:
    ds_read_b128 v[84:87], v1 offset:28672
    v_exp_f32 v109, v109
    v_mfma_f32_32x32x16_bf16 v[24:39], v[228:231], v[56:59], v[24:39]
    ds_read_b128 v[88:91], v1 offset:29696
    v_exp_f32 v110, v110
    v_exp_f32 v111, v111
    v_fma_f32 v104, v104, v137, v137
    v_mfma_f32_32x32x16_bf16 v[24:39], v[232:235], v[60:63], v[24:39]
    ds_read_b128 v[92:95], v1 offset:30720
    v_fma_f32 v105, v105, v137, v137
    v_fma_f32 v106, v106, v137, v137
    v_fma_f32 v107, v107, v137, v137
    v_fma_f32 v108, v108, v137, v137
    v_fma_f32 v109, v109, v137, v137
    v_fma_f32 v110, v110, v137, v137
    v_fma_f32 v111, v111, v137, v137
    v_mfma_f32_32x32x16_bf16 v[24:39], v[236:239], v[64:67], v[24:39]
    ds_read_b128 v[96:99], v1 offset:31744
    v_rcp_f32 v104, v104
    v_rcp_f32 v105, v105
    v_rcp_f32 v106, v106
    s_waitcnt lgkmcnt(4)
    v_mfma_f32_32x32x16_bf16 v[24:39], v[240:243], v[68:71], v[24:39]
    ds_read_b128 v[56:59], v1 offset:32768
    v_rcp_f32 v107, v107
    v_rcp_f32 v108, v108
    v_rcp_f32 v109, v109
    v_mfma_f32_32x32x16_bf16 v[24:39], v[244:247], v[72:75], v[24:39]
    ds_read_b128 v[60:63], v1 offset:33792
    v_rcp_f32 v110, v110
    v_rcp_f32 v111, v111
    v_mul_f32 v104, v104, v48
    v_mfma_f32_32x32x16_bf16 v[24:39], v[248:251], v[76:79], v[24:39]
    ds_read_b128 v[64:67], v1 offset:34816
    v_mul_f32 v105, v105, v49
    v_mul_f32 v106, v106, v50
    v_mul_f32 v107, v107, v51
    v_mul_f32 v108, v108, v52
    v_mul_f32 v109, v109, v53
    v_mul_f32 v110, v110, v54
    v_mul_f32 v111, v111, v55
    v_mfma_f32_32x32x16_bf16 v[24:39], v[252:255], v[80:83], v[24:39]
    ds_read_b128 v[68:71], v1 offset:35840
    v_cvt_pk_bf16_f32 v112, v104, v105
    v_cvt_pk_bf16_f32 v113, v106, v107
    v_cvt_pk_bf16_f32 v114, v108, v109
    v_cvt_pk_bf16_f32 v115, v110, v111
    buffer_store_dwordx4 v[100:103], v1, s[44:47], s15 offen sc1
    buffer_store_dwordx4 v[112:115], v11, s[44:47], s15 offen sc1
    s_waitcnt lgkmcnt(4)
    v_mfma_f32_32x32x16_bf16 v[40:55], v[144:147], v[84:87], 0
    ds_read_b128 v[72:75], v1 offset:36864
    v_mfma_f32_32x32x16_bf16 v[40:55], v[148:151], v[88:91], v[40:55]
    ds_read_b128 v[76:79], v1 offset:37888
    v_mfma_f32_32x32x16_bf16 v[40:55], v[152:155], v[92:95], v[40:55]
    ds_read_b128 v[80:83], v1 offset:38912
    v_mul_f32 v104, v24, v24
    v_mul_f32 v105, v25, v25
    v_mul_f32 v106, v26, v26
    v_mul_f32 v107, v27, v27
    v_mul_f32 v108, v28, v28
    v_mul_f32 v109, v29, v29
    v_mfma_f32_32x32x8_bf16 v[40:55], v[18:19], v[130:131], v[40:55]
    v_mul_f32 v110, v30, v30
    v_mul_f32 v111, v31, v31
    v_fma_f32 v104, v104, v139, v138
    v_fma_f32 v105, v105, v139, v138
    v_fma_f32 v106, v106, v139, v138
    v_fma_f32 v107, v107, v139, v138
    v_fma_f32 v108, v108, v139, v138
    v_mfma_f32_32x32x16_bf16 v[40:55], v[156:159], v[96:99], v[40:55]
    ds_read_b128 v[84:87], v1 offset:39936
    v_fma_f32 v109, v109, v139, v138
    v_fma_f32 v110, v110, v139, v138
    v_fma_f32 v111, v111, v139, v138
    v_mul_f32 v104, v104, v24
    v_mul_f32 v105, v105, v25
    s_waitcnt lgkmcnt(4)
    v_mfma_f32_32x32x16_bf16 v[40:55], v[160:163], v[56:59], v[40:55]
    ds_read_b128 v[88:91], v1 offset:40960
    v_mul_f32 v106, v106, v26
    v_mul_f32 v107, v107, v27
    v_mul_f32 v108, v108, v28
    v_mul_f32 v109, v109, v29
    v_mul_f32 v110, v110, v30
    v_mfma_f32_32x32x16_bf16 v[40:55], v[164:167], v[60:63], v[40:55]
    ds_read_b128 v[92:95], v1 offset:41984
    v_mul_f32 v111, v111, v31
    v_exp_f32 v104, v104
    v_exp_f32 v105, v105
    v_mfma_f32_32x32x16_bf16 v[40:55], v[168:171], v[64:67], v[40:55]
    ds_read_b128 v[96:99], v1 offset:43008
    v_exp_f32 v106, v106
    v_exp_f32 v107, v107
    v_exp_f32 v108, v108
    v_mfma_f32_32x32x16_bf16 v[40:55], v[172:175], v[68:71], v[40:55]
    ds_read_b128 v[56:59], v1 offset:44032
    v_exp_f32 v109, v109
    v_exp_f32 v110, v110
    v_exp_f32 v111, v111
    s_waitcnt lgkmcnt(4)
    v_mfma_f32_32x32x16_bf16 v[40:55], v[176:179], v[72:75], v[40:55]
    ds_read_b128 v[60:63], v1 offset:45056
    v_fma_f32 v104, v104, v140, v140
    v_fma_f32 v105, v105, v140, v140
    v_fma_f32 v106, v106, v140, v140
    v_fma_f32 v107, v107, v140, v140
    v_fma_f32 v108, v108, v140, v140
    v_mfma_f32_32x32x16_bf16 v[40:55], v[180:183], v[76:79], v[40:55]
    ds_read_b128 v[64:67], v1 offset:46080
    v_fma_f32 v109, v109, v140, v140
    v_fma_f32 v110, v110, v140, v140
    v_fma_f32 v111, v111, v140, v140
    v_rcp_f32 v104, v104
    v_rcp_f32 v105, v105
    v_mfma_f32_32x32x16_bf16 v[40:55], v[184:187], v[80:83], v[40:55]
    ds_read_b128 v[68:71], v1 offset:47104
    ds_read_b64 v[120:121], v16 offset:28672
    ds_read_b64 v[122:123], v16 offset:29184
    v_rcp_f32 v106, v106
    v_mfma_f32_32x32x16_bf16 v[40:55], v[188:191], v[84:87], v[40:55]
    ds_read_b128 v[72:75], v1 offset:48128
    v_rcp_f32 v107, v107
    v_rcp_f32 v108, v108
    v_rcp_f32 v109, v109
    s_waitcnt lgkmcnt(6)
    v_mfma_f32_32x32x16_bf16 v[40:55], v[192:195], v[88:91], v[40:55]
    ds_read_b128 v[76:79], v1 offset:49152
    v_rcp_f32 v110, v110
    v_rcp_f32 v111, v111
    v_mul_f32 v104, v104, v24
    v_mfma_f32_32x32x16_bf16 v[40:55], v[196:199], v[92:95], v[40:55]
    ds_read_b128 v[80:83], v1 offset:50176
    v_mul_f32 v105, v105, v25
    v_mul_f32 v106, v106, v26
    v_mul_f32 v107, v107, v27
    v_mul_f32 v108, v108, v28
    v_mul_f32 v109, v109, v29
    v_mul_f32 v110, v110, v30
    v_mfma_f32_32x32x16_bf16 v[40:55], v[200:203], v[96:99], v[40:55]
    ds_read_b128 v[84:87], v1 offset:51200
    v_mul_f32 v111, v111, v31
    v_cvt_pk_bf16_f32 v100, v104, v105
    v_cvt_pk_bf16_f32 v101, v106, v107
    v_cvt_pk_bf16_f32 v102, v108, v109
    v_cvt_pk_bf16_f32 v103, v110, v111
    v_mul_f32 v104, v32, v32
    v_mfma_f32_32x32x16_bf16 v[40:55], v[204:207], v[56:59], v[40:55]
    ds_read_b128 v[88:91], v1 offset:52224
    v_mul_f32 v105, v33, v33
    v_mul_f32 v106, v34, v34
    v_mul_f32 v107, v35, v35
    v_mul_f32 v108, v36, v36
    v_mul_f32 v109, v37, v37
    v_mul_f32 v110, v38, v38
    s_waitcnt lgkmcnt(4)
    v_mfma_f32_32x32x16_bf16 v[40:55], v[208:211], v[60:63], v[40:55]
    ds_read_b128 v[92:95], v1 offset:53248
    v_mul_f32 v111, v39, v39
    v_fma_f32 v104, v104, v139, v138
    v_fma_f32 v105, v105, v139, v138
    v_fma_f32 v106, v106, v139, v138
    v_mfma_f32_32x32x16_bf16 v[40:55], v[212:215], v[64:67], v[40:55]
    ds_read_b128 v[96:99], v1 offset:54272
    v_fma_f32 v107, v107, v139, v138
    v_fma_f32 v108, v108, v139, v138
    v_fma_f32 v109, v109, v139, v138
    v_fma_f32 v110, v110, v139, v138
    v_fma_f32 v111, v111, v139, v138
    v_mul_f32 v104, v104, v32
    v_mfma_f32_32x32x16_bf16 v[40:55], v[216:219], v[68:71], v[40:55]
    ds_read_b128 v[56:59], v1 offset:55296
    v_mul_f32 v105, v105, v33
    v_mul_f32 v106, v106, v34
    v_mul_f32 v107, v107, v35
    v_mul_f32 v108, v108, v36
    v_mul_f32 v109, v109, v37
    v_mul_f32 v110, v110, v38
    v_mfma_f32_32x32x16_bf16 v[40:55], v[220:223], v[72:75], v[40:55]
    ds_read_b128 v[60:63], v1 offset:56320
    v_mul_f32 v111, v111, v39
    v_exp_f32 v104, v104
    v_exp_f32 v105, v105
    s_waitcnt lgkmcnt(4)
    v_mfma_f32_32x32x16_bf16 v[40:55], v[224:227], v[76:79], v[40:55]
    v_exp_f32 v106, v106
    v_exp_f32 v107, v107
    v_exp_f32 v108, v108
    v_mfma_f32_32x32x16_bf16 v[40:55], v[228:231], v[80:83], v[40:55]
    v_exp_f32 v109, v109
    v_exp_f32 v110, v110
    v_exp_f32 v111, v111
    v_add_u32 v17, 4, v3
    v_mfma_f32_32x32x16_bf16 v[40:55], v[232:235], v[84:87], v[40:55]
    s_waitcnt vmcnt(0)
    buffer_store_dword v17, v8, s[44:47], s9 offen offset:512 sc1
    v_fma_f32 v104, v104, v140, v140
    v_fma_f32 v105, v105, v140, v140
    v_fma_f32 v106, v106, v140, v140
    v_fma_f32 v107, v107, v140, v140
    v_fma_f32 v108, v108, v140, v140
    v_mfma_f32_32x32x16_bf16 v[40:55], v[236:239], v[88:91], v[40:55]
    v_fma_f32 v109, v109, v140, v140
    v_fma_f32 v110, v110, v140, v140
    v_fma_f32 v111, v111, v140, v140
    v_rcp_f32 v104, v104
    v_rcp_f32 v105, v105
    s_waitcnt lgkmcnt(0)
    v_mfma_f32_32x32x16_bf16 v[40:55], v[240:243], v[92:95], v[40:55]
    v_rcp_f32 v106, v106
    v_rcp_f32 v107, v107
    v_rcp_f32 v108, v108
    v_mfma_f32_32x32x16_bf16 v[40:55], v[244:247], v[96:99], v[40:55]
    v_rcp_f32 v109, v109
    v_rcp_f32 v110, v110
    v_rcp_f32 v111, v111
    v_mfma_f32_32x32x16_bf16 v[40:55], v[248:251], v[56:59], v[40:55]
    v_mul_f32 v104, v104, v32
    v_mul_f32 v105, v105, v33
    v_mul_f32 v106, v106, v34
    v_mul_f32 v107, v107, v35
    v_mul_f32 v108, v108, v36
    v_mul_f32 v109, v109, v37
    v_mul_f32 v110, v110, v38
    v_mfma_f32_32x32x16_bf16 v[40:55], v[252:255], v[60:63], v[40:55]
    v_mul_f32 v111, v111, v39
    v_cvt_pk_bf16_f32 v112, v104, v105
    v_cvt_pk_bf16_f32 v113, v106, v107
    v_cvt_pk_bf16_f32 v114, v108, v109
    v_cvt_pk_bf16_f32 v115, v110, v111
    buffer_store_dwordx4 v[100:103], v1, s[44:47], s16 offen sc1
    buffer_store_dwordx4 v[112:115], v11, s[44:47], s16 offen sc1
    s_setprio 0
    v_lshlrev_b32 v20, 1, v7
    v_xor_b32 v20, v20, v6
    v_lshlrev_b32 v20, 4, v20
    v_lshl_add_u32 v20, v6, 8, v20
    s_lshl_b32 s4, s48, 13
    s_add_u32 s4, s4, 62464
    v_add_u32 v12, s4, v20
    v_xor_b32 v16, 16, v12
    v_add_u32 v10, 57344, v12
    v_add_u32 v15, 57344, v16
    v_mul_u32_u24 v20, 896, v6
    v_lshl_add_u32 v14, v7, 4, v20
    v_mul_f32 v104, v40, v40
    v_mul_f32 v105, v41, v41
    v_mul_f32 v106, v42, v42
    v_mul_f32 v107, v43, v43
    v_mul_f32 v108, v44, v44
    v_mul_f32 v109, v45, v45
    v_mul_f32 v110, v46, v46
    v_mul_f32 v111, v47, v47
    v_fma_f32 v104, v104, v142, v141
    v_fma_f32 v105, v105, v142, v141
    v_fma_f32 v106, v106, v142, v141
    v_fma_f32 v107, v107, v142, v141
    v_fma_f32 v108, v108, v142, v141
    v_fma_f32 v109, v109, v142, v141
    v_fma_f32 v110, v110, v142, v141
    v_fma_f32 v111, v111, v142, v141
    v_mul_f32 v104, v104, v40
    v_mul_f32 v105, v105, v41
    v_mul_f32 v106, v106, v42
    v_mul_f32 v107, v107, v43
    v_mul_f32 v108, v108, v44
    v_mul_f32 v109, v109, v45
    v_mul_f32 v110, v110, v46
    v_mul_f32 v111, v111, v47
    v_exp_f32 v104, v104
    v_exp_f32 v105, v105
    v_exp_f32 v106, v106
    v_exp_f32 v107, v107
    v_exp_f32 v108, v108
    v_exp_f32 v109, v109
    v_exp_f32 v110, v110
    v_exp_f32 v111, v111
    v_fma_f32 v104, v104, v143, v143
    v_fma_f32 v105, v105, v143, v143
    v_fma_f32 v106, v106, v143, v143
    v_fma_f32 v107, v107, v143, v143
    v_fma_f32 v108, v108, v143, v143
    v_fma_f32 v109, v109, v143, v143
    v_fma_f32 v110, v110, v143, v143
    v_fma_f32 v111, v111, v143, v143
    v_rcp_f32 v104, v104
    v_rcp_f32 v105, v105
    v_rcp_f32 v106, v106
    v_rcp_f32 v107, v107
    v_rcp_f32 v108, v108
    v_rcp_f32 v109, v109
    v_rcp_f32 v110, v110
    v_rcp_f32 v111, v111
    v_mul_f32 v104, v104, v40
    v_mul_f32 v105, v105, v41
    v_mul_f32 v106, v106, v42
    v_mul_f32 v107, v107, v43
    v_mul_f32 v108, v108, v44
    v_mul_f32 v109, v109, v45
    v_mul_f32 v110, v110, v46
    v_mul_f32 v111, v111, v47
    v_cvt_pk_bf16_f32 v100, v104, v105
    v_cvt_pk_bf16_f32 v101, v106, v107
    v_cvt_pk_bf16_f32 v102, v108, v109
    v_cvt_pk_bf16_f32 v103, v110, v111
    v_mul_f32 v104, v48, v48
    v_mul_f32 v105, v49, v49
    v_mul_f32 v106, v50, v50
    v_mul_f32 v107, v51, v51
    v_mul_f32 v108, v52, v52
    v_mul_f32 v109, v53, v53
    v_mul_f32 v110, v54, v54
    v_mul_f32 v111, v55, v55
    v_fma_f32 v104, v104, v142, v141
    v_fma_f32 v105, v105, v142, v141
    v_fma_f32 v106, v106, v142, v141
    v_fma_f32 v107, v107, v142, v141
    v_fma_f32 v108, v108, v142, v141
    v_fma_f32 v109, v109, v142, v141
    v_fma_f32 v110, v110, v142, v141
    v_fma_f32 v111, v111, v142, v141
    v_mul_f32 v104, v104, v48
    v_mul_f32 v105, v105, v49
    v_mul_f32 v106, v106, v50
    v_mul_f32 v107, v107, v51
    v_mul_f32 v108, v108, v52
    v_mul_f32 v109, v109, v53
    v_mul_f32 v110, v110, v54
    v_mul_f32 v111, v111, v55
    v_exp_f32 v104, v104
    v_exp_f32 v105, v105
    v_exp_f32 v106, v106
    v_exp_f32 v107, v107
    v_exp_f32 v108, v108
    v_exp_f32 v109, v109
    v_exp_f32 v110, v110
    v_exp_f32 v111, v111
    v_add_u32 v17, 6, v3
    s_waitcnt vmcnt(0)
    buffer_store_dword v17, v8, s[44:47], s9 offen offset:512 sc1
    v_fma_f32 v104, v104, v143, v143
    v_fma_f32 v105, v105, v143, v143
    v_fma_f32 v106, v106, v143, v143
    v_fma_f32 v107, v107, v143, v143
    v_fma_f32 v108, v108, v143, v143
    v_fma_f32 v109, v109, v143, v143
    v_fma_f32 v110, v110, v143, v143
    v_fma_f32 v111, v111, v143, v143
    v_rcp_f32 v104, v104
    v_rcp_f32 v105, v105
    v_rcp_f32 v106, v106
    v_rcp_f32 v107, v107
    v_rcp_f32 v108, v108
    v_rcp_f32 v109, v109
    v_rcp_f32 v110, v110
    v_rcp_f32 v111, v111
    v_mul_f32 v104, v104, v48
    v_mul_f32 v105, v105, v49
    v_mul_f32 v106, v106, v50
    v_mul_f32 v107, v107, v51
    v_mul_f32 v108, v108, v52
    v_mul_f32 v109, v109, v53
    v_mul_f32 v110, v110, v54
    v_mul_f32 v111, v111, v55
    v_cvt_pk_bf16_f32 v112, v104, v105
    v_cvt_pk_bf16_f32 v113, v106, v107
    v_cvt_pk_bf16_f32 v114, v108, v109
    v_cvt_pk_bf16_f32 v115, v110, v111
    buffer_store_dwordx4 v[100:103], v1, s[44:47], s18 offen sc1
    buffer_store_dwordx4 v[112:115], v11, s[44:47], s18 offen sc1
    v_lshlrev_b32 v124, 16, v116
    v_and_b32 v125, 0xffff0000, v116
    v_lshlrev_b32 v126, 16, v117
    v_and_b32 v127, 0xffff0000, v117
    v_lshlrev_b32 v128, 16, v118
    v_and_b32 v129, 0xffff0000, v118
    v_lshlrev_b32 v130, 16, v119
    v_and_b32 v131, 0xffff0000, v119
    v_lshlrev_b32 v132, 16, v120
    v_and_b32 v133, 0xffff0000, v120
    v_lshlrev_b32 v134, 16, v121
    v_and_b32 v135, 0xffff0000, v121
    v_lshlrev_b32 v136, 16, v122
    v_and_b32 v137, 0xffff0000, v122
    v_lshlrev_b32 v138, 16, v123
    v_and_b32 v139, 0xffff0000, v123
    v_min_u32 v23, 27, v0
    v_lshlrev_b32 v23, 2, v23
    v_add_u32 v17, 8, v3
    s_waitcnt vmcnt(0)
    buffer_store_dword v17, v8, s[44:47], s9 offen offset:512 sc1
    s_barrier
    ds_read_b128 v[56:59], v10 offset:0
    ds_read_b128 v[60:63], v15 offset:0
    ds_read_b128 v[64:67], v10 offset:2048
    ds_read_b128 v[68:71], v15 offset:2048
    ds_read_b128 v[72:75], v10 offset:4096
    ds_read_b128 v[76:79], v15 offset:4096
    ds_read_b128 v[80:83], v10 offset:6144
    ds_read_b128 v[84:87], v15 offset:6144
    buffer_load_dword v22, v23, s[44:47], s54 offen offset:1920 sc1
    s_waitcnt lgkmcnt(5)
    v_add_f32 v56, v56, v64
    v_add_f32 v57, v57, v65
    v_add_f32 v58, v58, v66
    v_add_f32 v59, v59, v67
    s_waitcnt lgkmcnt(4)
    v_add_f32 v60, v60, v68
    v_add_f32 v61, v61, v69
    v_add_f32 v62, v62, v70
    v_add_f32 v63, v63, v71
    s_waitcnt lgkmcnt(3)
    v_add_f32 v56, v56, v72
    v_add_f32 v57, v57, v73
    v_add_f32 v58, v58, v74
    v_add_f32 v59, v59, v75
    s_waitcnt lgkmcnt(2)
    v_add_f32 v60, v60, v76
    v_add_f32 v61, v61, v77
    v_add_f32 v62, v62, v78
    v_add_f32 v63, v63, v79
    s_waitcnt lgkmcnt(1)
    v_add_f32 v56, v56, v80
    v_add_f32 v57, v57, v81
    v_add_f32 v58, v58, v82
    v_add_f32 v59, v59, v83
    s_waitcnt lgkmcnt(0)
    v_add_f32 v60, v60, v84
    v_add_f32 v61, v61, v85
    v_add_f32 v62, v62, v86
    v_add_f32 v63, v63, v87
    v_cvt_pk_bf16_f32 v96, v56, v57
    v_cvt_pk_bf16_f32 v97, v58, v59
    v_cvt_pk_bf16_f32 v98, v60, v61
    v_cvt_pk_bf16_f32 v99, v62, v63
    s_waitcnt vmcnt(0)
    v_cmp_ne_u32 vcc, s53, v22
    s_cbranch_vccnz Lslowpoll_33
Lback_34:
    buffer_store_dwordx4 v[96:99], v14, s[40:43], s17 offen sc1
    s_add_u32 s17, s17, 28672
    s_barrier
    ds_read_b128 v[56:59], v12 offset:0
    ds_read_b128 v[60:63], v16 offset:0
    ds_read_b128 v[64:67], v12 offset:2048
    ds_read_b128 v[68:71], v16 offset:2048
    ds_read_b128 v[72:75], v12 offset:4096
    ds_read_b128 v[76:79], v16 offset:4096
    ds_read_b128 v[80:83], v12 offset:6144
    ds_read_b128 v[84:87], v16 offset:6144
    s_waitcnt lgkmcnt(5)
    v_add_f32 v56, v56, v64
    v_add_f32 v57, v57, v65
    v_add_f32 v58, v58, v66
    v_add_f32 v59, v59, v67
    s_waitcnt lgkmcnt(4)
    v_add_f32 v60, v60, v68
    v_add_f32 v61, v61, v69
    v_add_f32 v62, v62, v70
    v_add_f32 v63, v63, v71
    s_waitcnt lgkmcnt(3)
    v_add_f32 v56, v56, v72
    v_add_f32 v57, v57, v73
    v_add_f32 v58, v58, v74
    v_add_f32 v59, v59, v75
    s_waitcnt lgkmcnt(2)
    v_add_f32 v60, v60, v76
    v_add_f32 v61, v61, v77
    v_add_f32 v62, v62, v78
    v_add_f32 v63, v63, v79
    s_waitcnt lgkmcnt(1)
    v_add_f32 v56, v56, v80
    v_add_f32 v57, v57, v81
    v_add_f32 v58, v58, v82
    v_add_f32 v59, v59, v83
    s_waitcnt lgkmcnt(0)
    v_add_f32 v60, v60, v84
    v_add_f32 v61, v61, v85
    v_add_f32 v62, v62, v86
    v_add_f32 v63, v63, v87
    v_cvt_pk_bf16_f32 v100, v56, v57
    v_cvt_pk_bf16_f32 v101, v58, v59
    v_cvt_pk_bf16_f32 v102, v60, v61
    v_cvt_pk_bf16_f32 v103, v62, v63
    buffer_store_dwordx4 v[100:103], v14, s[40:43], s17 offen sc1
    s_waitcnt vmcnt(0)
    buffer_store_dword v3, v8, s[44:47], s12 offen offset:1024 sc1
    s_barrier
    ds_read_b128 v[56:59], v10 offset:0
    ds_read_b128 v[60:63], v15 offset:0
    ds_read_b128 v[64:67], v10 offset:2048
    ds_read_b128 v[68:71], v15 offset:2048
    ds_read_b128 v[72:75], v10 offset:4096
    ds_read_b128 v[76:79], v15 offset:4096
    ds_read_b128 v[80:83], v10 offset:6144
    ds_read_b128 v[84:87], v15 offset:6144
    buffer_load_dword v22, v2, s[44:47], s13 offen offset:1024 sc1
    s_waitcnt lgkmcnt(7)
    v_add_f32 v56, v56, v124
    v_add_f32 v57, v57, v125
    v_add_f32 v58, v58, v126
    v_add_f32 v59, v59, v127
    s_waitcnt lgkmcnt(6)
    v_add_f32 v60, v60, v128
    v_add_f32 v61, v61, v129
    v_add_f32 v62, v62, v130
    v_add_f32 v63, v63, v131
    s_waitcnt lgkmcnt(5)
    v_add_f32 v56, v56, v64
    v_add_f32 v57, v57, v65
    v_add_f32 v58, v58, v66
    v_add_f32 v59, v59, v67
    s_waitcnt lgkmcnt(4)
    v_add_f32 v60, v60, v68
    v_add_f32 v61, v61, v69
    v_add_f32 v62, v62, v70
    v_add_f32 v63, v63, v71
    s_waitcnt lgkmcnt(3)
    v_add_f32 v56, v56, v72
    v_add_f32 v57, v57, v73
    v_add_f32 v58, v58, v74
    v_add_f32 v59, v59, v75
    s_waitcnt lgkmcnt(2)
    v_add_f32 v60, v60, v76
    v_add_f32 v61, v61, v77
    v_add_f32 v62, v62, v78
    v_add_f32 v63, v63, v79
    s_waitcnt lgkmcnt(1)
    v_add_f32 v24, v56, v80
    v_add_f32 v25, v57, v81
    v_add_f32 v26, v58, v82
    v_add_f32 v27, v59, v83
    s_waitcnt lgkmcnt(0)
    v_add_f32 v28, v60, v84
    v_add_f32 v29, v61, v85
    v_add_f32 v30, v62, v86
    v_add_f32 v31, v63, v87
    s_waitcnt vmcnt(0)
    v_cmp_ne_u32 vcc, s53, v22
    s_cbranch_vccnz Lslowpoll_35
Lback_36:
    s_add_u32 s4, s7, 28672
    buffer_load_dwordx4 v[88:91], v14, s[40:43], s7 offen sc1
    buffer_load_dwordx4 v[92:95], v14, s[40:43], s4 offen sc1
    s_waitcnt vmcnt(0)
    v_lshlrev_b32 v20, 16, v92
    v_and_b32 v21, 0xffff0000, v92
    v_add_f32 v132, v132, v20
    v_add_f32 v133, v133, v21
    v_lshlrev_b32 v20, 16, v93
    v_and_b32 v21, 0xffff0000, v93
    v_add_f32 v134, v134, v20
    v_add_f32 v135, v135, v21
    v_lshlrev_b32 v20, 16, v94
    v_and_b32 v21, 0xffff0000, v94
    v_add_f32 v136, v136, v20
    v_add_f32 v137, v137, v21
    v_lshlrev_b32 v20, 16, v95
    v_and_b32 v21, 0xffff0000, v95
    v_add_f32 v138, v138, v20
    v_add_f32 v139, v139, v21
    s_barrier
    ds_read_b128 v[56:59], v12 offset:0
    ds_read_b128 v[60:63], v16 offset:0
    ds_read_b128 v[64:67], v12 offset:2048
    ds_read_b128 v[68:71], v16 offset:2048
    ds_read_b128 v[72:75], v12 offset:4096
    ds_read_b128 v[76:79], v16 offset:4096
    ds_read_b128 v[80:83], v12 offset:6144
    ds_read_b128 v[84:87], v16 offset:6144
    v_lshlrev_b32 v20, 16, v88
    v_and_b32 v21, 0xffff0000, v88
    v_add_f32 v24, v24, v20
    v_add_f32 v25, v25, v21
    v_lshlrev_b32 v20, 16, v89
    v_and_b32 v21, 0xffff0000, v89
    v_add_f32 v26, v26, v20
    v_add_f32 v27, v27, v21
    v_lshlrev_b32 v20, 16, v90
    v_and_b32 v21, 0xffff0000, v90
    v_add_f32 v28, v28, v20
    v_add_f32 v29, v29, v21
    v_lshlrev_b32 v20, 16, v91
    v_and_b32 v21, 0xffff0000, v91
    v_add_f32 v30, v30, v20
    v_add_f32 v31, v31, v21
    v_cvt_pk_bf16_f32 v96, v24, v25
    v_cvt_pk_bf16_f32 v97, v26, v27
    v_cvt_pk_bf16_f32 v98, v28, v29
    v_cvt_pk_bf16_f32 v99, v30, v31
    buffer_store_dwordx4 v[96:99], v14, s[40:43], s7 offen
    s_add_u32 s7, s7, 28672
    s_waitcnt lgkmcnt(7)
    v_pk_add_f32 v[56:57], v[56:57], v[132:133]
    v_pk_add_f32 v[58:59], v[58:59], v[134:135]
    s_waitcnt lgkmcnt(6)
    v_pk_add_f32 v[60:61], v[60:61], v[136:137]
    v_pk_add_f32 v[62:63], v[62:63], v[138:139]
    s_waitcnt lgkmcnt(5)
    v_pk_add_f32 v[56:57], v[56:57], v[64:65]
    v_pk_add_f32 v[58:59], v[58:59], v[66:67]
    s_waitcnt lgkmcnt(4)
    v_pk_add_f32 v[60:61], v[60:61], v[68:69]
    v_pk_add_f32 v[62:63], v[62:63], v[70:71]
    s_waitcnt lgkmcnt(3)
    v_pk_add_f32 v[56:57], v[56:57], v[72:73]
    v_pk_add_f32 v[58:59], v[58:59], v[74:75]
    s_waitcnt lgkmcnt(2)
    v_pk_add_f32 v[60:61], v[60:61], v[76:77]
    v_pk_add_f32 v[62:63], v[62:63], v[78:79]
    s_waitcnt lgkmcnt(1)
    v_pk_add_f32 v[56:57], v[56:57], v[80:81]
    v_pk_add_f32 v[58:59], v[58:59], v[82:83]
    s_waitcnt lgkmcnt(0)
    v_pk_add_f32 v[60:61], v[60:61], v[84:85]
    v_pk_add_f32 v[62:63], v[62:63], v[86:87]
    v_cvt_pk_bf16_f32 v100, v56, v57
    v_cvt_pk_bf16_f32 v101, v58, v59
    v_cvt_pk_bf16_f32 v102, v60, v61
    v_cvt_pk_bf16_f32 v103, v62, v63
    buffer_store_dwordx4 v[100:103], v14, s[40:43], s7 offen
    s_endpgm
LB_slow:
    s_waitcnt vmcnt(0) lgkmcnt(0)
    s_nop 15
    v_mov_b32 v248, 0x3f803f80
    s_barrier
Lpoll_37:
    buffer_load_dword v20, v19, s[44:47], s54 offen offset:0 sc1
    s_add_u32 s59, s59, 1
    s_cmp_gt_u32 s59, 0x100000
    s_cbranch_scc1 Lend
    s_sleep 8
    s_waitcnt vmcnt(0)
    v_cmp_ne_u32 vcc, s53, v20
    s_cbranch_vccnz Lpoll_37
    buffer_load_dwordx4 v[200:203], v23, s[40:43], s17 offen offset:0 sc1
    v_and_b32 v20, 31, v0
    v_min_u32 v20, 27, v20
    v_lshrrev_b32 v21, 5, v0
    v_lshlrev_b32 v21, 19, v21
    v_lshl_add_u32 v19, v20, 2, v21
    v_and_b32 v20, 2, v6
    v_lshlrev_b32 v20, 1, v20
    v_xor_b32 v20, v20, v7
    buffer_load_dwordx4 v[204:207], v23, s[40:43], s17 offen offset:1024 sc1
    v_lshlrev_b32 v20, 4, v20
    v_mul_u32_u24 v21, 896, v6
    v_add_u32 v20, v20, v21
    s_mul_i32 s4, s52, 28
    s_add_u32 s4, s4, s48
    s_mul_i32 s4, s4, 224
    s_add_u32 s4, s4, s49
    s_lshl_b32 s4, s4, 7
    buffer_load_dwordx4 v[208:211], v23, s[40:43], s18 offen offset:0 sc1
    v_add_u32 v11, s4, v20
    v_add_u32 v12, 6144, v11
    v_lshrrev_b32 v20, 2, v4
    v_and_b32 v21, 3, v4
    v_lshrrev_b32 v22, 1, v20
    v_lshlrev_b32 v22, 6, v22
    v_lshl_add_u32 v22, v21, 3, v22
    v_and_b32 v244, 1, v5
    buffer_load_dwordx4 v[212:215], v23, s[40:43], s18 offen offset:1024 sc1
    v_lshl_add_u32 v22, v244, 5, v22
    v_lshrrev_b32 v244, 1, v5
    v_lshl_add_u32 v244, v244, 2, v20
    v_lshl_add_u32 v22, v244, 7, v22
    v_add_u32 v13, s16, v22
    v_xor_b32 v14, 64, v13
    v_lshrrev_b32 v21, 5, v0
    v_xor_b32 v21, v21, v7
    buffer_load_dwordx4 v[216:219], v23, s[40:43], s19 offen offset:0 sc1
    v_lshlrev_b32 v21, 4, v21
    v_lshl_add_u32 v21, v7, 8, v21
    v_and_b32 v20, 3, v6
    v_lshl_add_u32 v20, v20, 13, v21
    v_add_u32 v240, s16, v20
    v_xor_b32 v241, 32, v240
    v_xor_b32 v242, 64, v240
    v_xor_b32 v243, 96, v240
    buffer_load_dwordx4 v[220:223], v23, s[40:43], s19 offen offset:1024 sc1
    v_min_u32 v9, 6, v0
    v_lshlrev_b32 v9, 2, v9
    s_add_u32 s4, s54, 4096
    s_add_u32 s4, s4, s58
    v_add_u32 v7, s4, v1
    s_add_u32 s4, s55, 4096
    s_add_u32 s4, s4, s58
    v_add_u32 v21, s4, v1
    buffer_load_dwordx4 v[224:227], v23, s[40:43], s8 offen offset:0 sc1
    s_lshl_b32 s10, s48, 7
    s_add_u32 s10, s10, s54
    s_mul_i32 s56, s48, 14336
    s_add_u32 s56, s56, s54
    s_add_u32 s12, s54, s58
    s_add_u32 s50, s55, s58
    s_lshl_b32 s51, s48, 2
    v_mov_b32 v22, v23
    buffer_load_dwordx4 v[228:231], v23, s[40:43], s8 offen offset:1024 sc1
    s_add_u32 s4, s56, 122880
    v_add_u32 v4, s4, v1
    s_add_u32 s4, s56, 180224
    v_add_u32 v5, s4, v1
    s_add_u32 s4, s56, 237568
    v_add_u32 v6, s4, v1
    s_waitcnt vmcnt(7)
    v_mfma_f32_16x16x32_bf16 v[24:27], v[40:43], v[200:203], v[24:27]
    buffer_load_dwordx4 v[232:235], v23, s[40:43], s3 offen offset:0 sc1
    v_mfma_f32_16x16x32_bf16 v[28:31], v[44:47], v[200:203], v[28:31]
    v_mfma_f32_16x16x32_bf16 v[32:35], v[48:51], v[200:203], v[32:35]
    v_mfma_f32_16x16x32_bf16 v[36:39], v[52:55], v[200:203], v[36:39]
    s_waitcnt vmcnt(7)
    v_mfma_f32_16x16x32_bf16 v[24:27], v[56:59], v[204:207], v[24:27]
    buffer_load_dwordx4 v[236:239], v23, s[40:43], s3 offen offset:1024 sc1
    ds_read_b64_tr_b16 v[40:41], v252 offset:0
    ds_read_b64_tr_b16 v[42:43], v252 offset:1024
    ds_read_b64_tr_b16 v[44:45], v253 offset:0
    ds_read_b64_tr_b16 v[46:47], v253 offset:1024
    ds_read_b64_tr_b16 v[48:49], v254 offset:0
    v_mfma_f32_16x16x32_bf16 v[28:31], v[60:63], v[204:207], v[28:31]
    ds_read_b64_tr_b16 v[50:51], v254 offset:1024
    v_mfma_f32_16x16x32_bf16 v[32:35], v[64:67], v[204:207], v[32:35]
    ds_read_b64_tr_b16 v[52:53], v255 offset:0
    v_mfma_f32_16x16x32_bf16 v[36:39], v[68:71], v[204:207], v[36:39]
    ds_read_b64_tr_b16 v[54:55], v255 offset:1024
    s_waitcnt vmcnt(7)
    v_mfma_f32_16x16x32_bf16 v[24:27], v[72:75], v[208:211], v[24:27]
    buffer_load_dwordx4 v[200:203], v23, s[40:43], s57 offen offset:0 sc1
    v_mfma_f32_16x16x32_bf16 v[28:31], v[76:79], v[208:211], v[28:31]
    ds_read_b64_tr_b16 v[56:57], v252 offset:4096
    v_mfma_f32_16x16x32_bf16 v[32:35], v[80:83], v[208:211], v[32:35]
    ds_read_b64_tr_b16 v[58:59], v252 offset:5120
    v_mfma_f32_16x16x32_bf16 v[36:39], v[84:87], v[208:211], v[36:39]
    ds_read_b64_tr_b16 v[60:61], v253 offset:4096
    s_waitcnt vmcnt(7)
    v_mfma_f32_16x16x32_bf16 v[24:27], v[88:91], v[212:215], v[24:27]
    buffer_load_dwordx4 v[204:207], v23, s[40:43], s57 offen offset:1024 sc1
    ds_read_b64_tr_b16 v[62:63], v253 offset:5120
    v_mfma_f32_16x16x32_bf16 v[28:31], v[92:95], v[212:215], v[28:31]
    ds_read_b64_tr_b16 v[64:65], v254 offset:4096
    v_mfma_f32_16x16x32_bf16 v[32:35], v[96:99], v[212:215], v[32:35]
    ds_read_b64_tr_b16 v[66:67], v254 offset:5120
    v_mfma_f32_16x16x32_bf16 v[36:39], v[100:103], v[212:215], v[36:39]
    ds_read_b64_tr_b16 v[68:69], v255 offset:4096
    s_waitcnt vmcnt(7)
    v_mfma_f32_16x16x32_bf16 v[24:27], v[104:107], v[216:219], v[24:27]
    buffer_load_dwordx4 v[208:211], v23, s[40:43], s9 offen offset:0 sc1
    ds_read_b64_tr_b16 v[70:71], v255 offset:5120
    v_mfma_f32_16x16x32_bf16 v[28:31], v[108:111], v[216:219], v[28:31]
    v_mfma_f32_16x16x32_bf16 v[32:35], v[112:115], v[216:219], v[32:35]
    ds_read_b64_tr_b16 v[72:73], v252 offset:8192
    v_mfma_f32_16x16x32_bf16 v[36:39], v[116:119], v[216:219], v[36:39]
    ds_read_b64_tr_b16 v[74:75], v252 offset:9216
    s_waitcnt vmcnt(7)
    v_mfma_f32_16x16x32_bf16 v[24:27], v[120:123], v[220:223], v[24:27]
    buffer_load_dwordx4 v[212:215], v23, s[40:43], s9 offen offset:1024 sc1
    ds_read_b64_tr_b16 v[76:77], v253 offset:8192
    v_mfma_f32_16x16x32_bf16 v[28:31], v[124:127], v[220:223], v[28:31]
    ds_read_b64_tr_b16 v[78:79], v253 offset:9216
    v_mfma_f32_16x16x32_bf16 v[32:35], v[128:131], v[220:223], v[32:35]
    ds_read_b64_tr_b16 v[80:81], v254 offset:8192
    v_mfma_f32_16x16x32_bf16 v[36:39], v[132:135], v[220:223], v[36:39]
    ds_read_b64_tr_b16 v[82:83], v254 offset:9216
    s_waitcnt vmcnt(7)
    v_mfma_f32_16x16x32_bf16 v[24:27], v[136:139], v[224:227], v[24:27]
    ds_read_b64_tr_b16 v[84:85], v255 offset:8192
    s_add_u32 m0, s58, 8192
    v_mfma_f32_16x16x32_bf16 v[28:31], v[140:143], v[224:227], v[28:31]
    ds_read_b64_tr_b16 v[86:87], v255 offset:9216
    s_mov_b32 s5, 688128
    v_mfma_f32_16x16x32_bf16 v[32:35], v[144:147], v[224:227], v[32:35]
    buffer_load_dwordx4 v10, s[32:35], s5 offen  lds
    v_mfma_f32_16x16x32_bf16 v[36:39], v[148:151], v[224:227], v[36:39]
    ds_read_b64_tr_b16 v[88:89], v252 offset:12288
    s_waitcnt vmcnt(7)
    v_mfma_f32_16x16x32_bf16 v[24:27], v[152:155], v[228:231], v[24:27]
    ds_read_b64_tr_b16 v[90:91], v252 offset:13312
    s_add_u32 m0, s58, 12288
    v_mfma_f32_16x16x32_bf16 v[28:31], v[156:159], v[228:231], v[28:31]
    ds_read_b64_tr_b16 v[92:93], v253 offset:12288
    s_mov_b32 s5, 745472
    v_mfma_f32_16x16x32_bf16 v[32:35], v[160:163], v[228:231], v[32:35]
    ds_read_b64_tr_b16 v[94:95], v253 offset:13312
    buffer_load_dwordx4 v10, s[32:35], s5 offen  lds
    v_mfma_f32_16x16x32_bf16 v[36:39], v[164:167], v[228:231], v[36:39]
    ds_read_b64_tr_b16 v[96:97], v254 offset:12288
    s_waitcnt vmcnt(7)
    v_mfma_f32_16x16x32_bf16 v[24:27], v[168:171], v[232:235], v[24:27]
    ds_read_b64_tr_b16 v[98:99], v254 offset:13312
    s_add_u32 m0, s58, 16384
    v_mfma_f32_16x16x32_bf16 v[28:31], v[172:175], v[232:235], v[28:31]
    ds_read_b64_tr_b16 v[100:101], v255 offset:12288
    s_mov_b32 s5, 802816
    v_mfma_f32_16x16x32_bf16 v[32:35], v[176:179], v[232:235], v[32:35]
    ds_read_b64_tr_b16 v[102:103], v255 offset:13312
    buffer_load_dwordx4 v10, s[32:35], s5 offen  lds
    v_mfma_f32_16x16x32_bf16 v[36:39], v[180:183], v[232:235], v[36:39]
    s_waitcnt vmcnt(7)
    v_mfma_f32_16x16x32_bf16 v[24:27], v[184:187], v[236:239], v[24:27]
    s_add_u32 m0, s58, 20480
    v_mfma_f32_16x16x32_bf16 v[28:31], v[188:191], v[236:239], v[28:31]
    s_mov_b32 s5, 860160
    v_mfma_f32_16x16x32_bf16 v[32:35], v[192:195], v[236:239], v[32:35]
    buffer_load_dwordx4 v10, s[32:35], s5 offen  lds
    v_mfma_f32_16x16x32_bf16 v[36:39], v[196:199], v[236:239], v[36:39]
    s_waitcnt lgkmcnt(14)
    s_waitcnt vmcnt(7)
    v_mfma_f32_16x16x32_bf16 v[24:27], v[40:43], v[200:203], v[24:27]
    s_add_u32 m0, s58, 24576
    v_mfma_f32_16x16x32_bf16 v[28:31], v[44:47], v[200:203], v[28:31]
    s_mov_b32 s5, 917504
    v_mfma_f32_16x16x32_bf16 v[32:35], v[48:51], v[200:203], v[32:35]
    buffer_load_dwordx4 v10, s[32:35], s5 offen  lds
    v_mfma_f32_16x16x32_bf16 v[36:39], v[52:55], v[200:203], v[36:39]
    s_waitcnt vmcnt(7)
    v_mfma_f32_16x16x32_bf16 v[24:27], v[56:59], v[204:207], v[24:27]
    s_add_u32 m0, s58, 28672
    v_mfma_f32_16x16x32_bf16 v[28:31], v[60:63], v[204:207], v[28:31]
    s_mov_b32 s5, 974848
    v_mfma_f32_16x16x32_bf16 v[32:35], v[64:67], v[204:207], v[32:35]
    buffer_load_dwordx4 v10, s[32:35], s5 offen  lds
    v_mfma_f32_16x16x32_bf16 v[36:39], v[68:71], v[204:207], v[36:39]
    s_waitcnt lgkmcnt(8)
    s_waitcnt vmcnt(7)
    v_mfma_f32_16x16x32_bf16 v[24:27], v[72:75], v[208:211], v[24:27]
    s_add_u32 m0, s58, 32768
    v_mfma_f32_16x16x32_bf16 v[28:31], v[76:79], v[208:211], v[28:31]
    s_mov_b32 s5, 1032192
    v_mfma_f32_16x16x32_bf16 v[32:35], v[80:83], v[208:211], v[32:35]
    buffer_load_dwordx4 v10, s[32:35], s5 offen  lds
    v_mfma_f32_16x16x32_bf16 v[36:39], v[84:87], v[208:211], v[36:39]
    s_waitcnt lgkmcnt(0)
    s_waitcnt vmcnt(7)
    v_mfma_f32_16x16x32_bf16 v[24:27], v[88:91], v[212:215], v[24:27]
    s_add_u32 m0, s58, 36864
    v_mfma_f32_16x16x32_bf16 v[28:31], v[92:95], v[212:215], v[28:31]
    s_mov_b32 s5, 1089536
    v_mfma_f32_16x16x32_bf16 v[32:35], v[96:99], v[212:215], v[32:35]
    buffer_load_dwordx4 v10, s[32:35], s5 offen  lds
    v_mfma_f32_16x16x32_bf16 v[36:39], v[100:103], v[212:215], v[36:39]
    s_nop 1
    v_cvt_pk_bf16_f32 v40, v24, v25
    v_cvt_pk_bf16_f32 v41, v26, v27
    v_cvt_pk_bf16_f32 v42, v28, v29
    v_cvt_pk_bf16_f32 v43, v30, v31
    v_cvt_pk_bf16_f32 v44, v32, v33
    v_cvt_pk_bf16_f32 v45, v34, v35
    v_cvt_pk_bf16_f32 v46, v36, v37
    v_cvt_pk_bf16_f32 v47, v38, v39
    buffer_store_dwordx4 v[40:43], v249, s[44:47], s13 offen offset:0 sc1
    buffer_store_dwordx4 v[44:47], v249, s[44:47], s13 offen offset:2048 sc1
    v_dot2_f32_bf16 v48, v40, v248, 0
    v_dot2_f32_bf16 v49, v40, v40, 0
    v_dot2_f32_bf16 v50, v41, v248, 0
    v_dot2_f32_bf16 v51, v41, v41, 0
    v_dot2_f32_bf16 v48, v42, v248, v48
    v_dot2_f32_bf16 v49, v42, v42, v49
    v_dot2_f32_bf16 v50, v43, v248, v50
    v_dot2_f32_bf16 v51, v43, v43, v51
    v_dot2_f32_bf16 v48, v44, v248, v48
    v_dot2_f32_bf16 v49, v44, v44, v49
    v_dot2_f32_bf16 v50, v45, v248, v50
    v_dot2_f32_bf16 v51, v45, v45, v51
    v_dot2_f32_bf16 v48, v46, v248, v48
    v_dot2_f32_bf16 v49, v46, v46, v49
    v_dot2_f32_bf16 v50, v47, v248, v50
    v_dot2_f32_bf16 v51, v47, v47, v51
    s_nop 1
    v_add_f32 v48, v48, v50
    v_add_f32 v49, v49, v51
    s_nop 1
    v_permlane32_swap_b32 v48, v49
    v_add_f32 v48, v48, v49
    v_mov_b32 v49, v48
    s_nop 1
    v_permlane16_swap_b32 v48, v49
    v_add_f32 v48, v48, v49
    buffer_store_dword v48, v250, s[44:47], s14 offen sc1
    s_add_u32 m0, s58, 40960
    s_mov_b32 s5, 1146880
    buffer_load_dwordx4 v10, s[32:35], s5 offen  lds
    s_add_u32 m0, s58, 45056
    s_mov_b32 s5, 1204224
    buffer_load_dwordx4 v10, s[32:35], s5 offen  lds
    s_add_u32 m0, s58, 49152
    s_mov_b32 s5, 1261568
    buffer_load_dwordx4 v10, s[32:35], s5 offen  lds
    s_add_u32 m0, s58, 53248
    s_mov_b32 s5, 1318912
    buffer_load_dwordx4 v10, s[32:35], s5 offen  lds
    s_add_u32 m0, s58, 119808
    s_mov_b32 s5, 1376256
    buffer_load_dwordx4 v10, s[32:35], s5 offen  lds
    s_add_u32 m0, s58, 123904
    s_mov_b32 s5, 1433600
    buffer_load_dwordx4 v10, s[32:35], s5 offen  lds
    s_add_u32 m0, s58, 128000
    s_mov_b32 s5, 1490944
    buffer_load_dwordx4 v10, s[32:35], s5 offen  lds
    s_add_u32 m0, s58, 132096
    s_mov_b32 s5, 1548288
    buffer_load_dwordx4 v10, s[32:35], s5 offen  lds
    v_mov_b32 v16, v240
    v_mov_b32 v17, v241
    v_mov_b32 v18, v242
    v_mov_b32 v23, v243
    s_mov_b32 s60, 0
    s_mov_b32 s61, 1024
    s_mov_b32 s62, 2048
    s_mov_b32 s63, 3072
    s_mov_b32 s64, 4096
    s_mov_b32 s65, 5120
    s_mov_b32 s66, 6144
    s_waitcnt vmcnt(8)
    buffer_store_dword v3, v8, s[44:47], s15 offen offset:128 sc1
    s_waitcnt vmcnt(1)
    s_barrier
Lpoll_38:
    buffer_load_dword v20, v19, s[44:47], s7 offen offset:128 sc1
    s_add_u32 s59, s59, 1
    s_cmp_gt_u32 s59, 0x100000
    s_cbranch_scc1 Lend
    s_sleep 8
    s_waitcnt vmcnt(0)
    v_cmp_ne_u32 vcc, s53, v20
    s_cbranch_vccnz Lpoll_38
    s_add_u32 m0, s58, 62464
    s_lshl1_add_u32 s4, s17, 0
    buffer_load_dwordx4 v7, s[44:47], s4 offen sc1 lds
    s_add_u32 m0, s58, 66560
    s_lshl1_add_u32 s4, s18, 0
    buffer_load_dwordx4 v7, s[44:47], s4 offen sc1 lds
    s_add_u32 m0, s58, 70656
    s_lshl1_add_u32 s4, s19, 0
    buffer_load_dwordx4 v7, s[44:47], s4 offen sc1 lds
    s_add_u32 m0, s58, 74752
    s_lshl1_add_u32 s4, s8, 0
    buffer_load_dwordx4 v7, s[44:47], s4 offen sc1 lds
    s_cmp_eq_u32 s48, 3
    s_cselect_b32 exec_hi, 0, -1
    s_add_u32 m0, s58, 57344
    s_add_u32 s5, s12, 61440
    buffer_load_dwordx4 v1, s[44:47], s5 offen sc1 lds
    s_add_u32 s4, s58, 159744
    s_cmp_eq_u32 s48, 0
    s_cselect_b32 m0, 61440, s4
    s_add_u32 s5, s50, 61440
    buffer_load_dwordx4 v1, s[44:47], s5 offen sc1 lds
    s_mov_b64 exec, -1
    s_add_u32 m0, s58, 78848
    s_lshl1_add_u32 s4, s3, 0
    buffer_load_dwordx4 v7, s[44:47], s4 offen sc1 lds
    s_add_u32 m0, s58, 82944
    s_lshl1_add_u32 s4, s57, 0
    buffer_load_dwordx4 v7, s[44:47], s4 offen sc1 lds
    s_add_u32 m0, s58, 87040
    s_lshl1_add_u32 s4, s9, 0
    buffer_load_dwordx4 v7, s[44:47], s4 offen sc1 lds
    s_add_u32 m0, s51, 163200
    s_mov_b64 exec, 1
    buffer_load_dword v2, s[44:47], s15 offen offset:128 sc1 lds
    s_mov_b64 exec, -1
    s_add_u32 m0, s58, 91136
    s_lshl1_add_u32 s4, s17, 28672
    buffer_load_dwordx4 v7, s[44:47], s4 offen sc1 lds
    s_add_u32 m0, s58, 95232
    s_lshl1_add_u32 s4, s18, 28672
    buffer_load_dwordx4 v7, s[44:47], s4 offen sc1 lds
    s_add_u32 m0, s58, 99328
    s_lshl1_add_u32 s4, s19, 28672
    buffer_load_dwordx4 v7, s[44:47], s4 offen sc1 lds
    s_waitcnt vmcnt(7)
    s_barrier
    s_setprio 0
    s_add_u32 m0, s58, 103424
    s_lshl1_add_u32 s4, s8, 28672
    buffer_load_dwordx4 v7, s[44:47], s4 offen sc1 lds
    s_add_u32 m0, s58, 107520
    s_lshl1_add_u32 s4, s3, 28672
    buffer_load_dwordx4 v7, s[44:47], s4 offen sc1 lds
    s_add_u32 m0, s58, 111616
    s_lshl1_add_u32 s4, s57, 28672
    buffer_load_dwordx4 v7, s[44:47], s4 offen sc1 lds
    s_add_u32 m0, s58, 115712
    s_lshl1_add_u32 s4, s9, 28672
    buffer_load_dwordx4 v7, s[44:47], s4 offen sc1 lds
    s_add_u32 m0, s51, 163216
    s_mov_b64 exec, 1
    buffer_load_dword v2, s[44:47], s15 offen offset:128 sc1 lds
    s_mov_b64 exec, -1
    s_add_u32 m0, s58, 0
    s_lshl1_add_u32 s4, s17, 0
    buffer_load_dwordx4 v21, s[44:47], s4 offen sc1 lds
    s_add_u32 m0, s58, 4096
    s_lshl1_add_u32 s4, s18, 0
    buffer_load_dwordx4 v21, s[44:47], s4 offen sc1 lds
    s_add_u32 m0, s58, 8192
    s_lshl1_add_u32 s4, s19, 0
    buffer_load_dwordx4 v21, s[44:47], s4 offen sc1 lds
    s_add_u32 m0, s58, 12288
    s_lshl1_add_u32 s4, s8, 0
    buffer_load_dwordx4 v21, s[44:47], s4 offen sc1 lds
    s_add_u32 m0, s58, 16384
    s_lshl1_add_u32 s4, s3, 0
    buffer_load_dwordx4 v21, s[44:47], s4 offen sc1 lds
    s_add_u32 m0, s58, 20480
    s_lshl1_add_u32 s4, s57, 0
    buffer_load_dwordx4 v21, s[44:47], s4 offen sc1 lds
    s_add_u32 m0, s58, 24576
    s_lshl1_add_u32 s4, s9, 0
    buffer_load_dwordx4 v21, s[44:47], s4 offen sc1 lds
    s_add_u32 m0, s51, 163232
    s_mov_b64 exec, 1
    buffer_load_dword v2, s[44:47], s15 offen offset:128 sc1 lds
    s_mov_b64 exec, -1
    v_min_u32 v10, 2, v0
    s_mul_i32 s4, s48, 384
    v_lshl_add_u32 v10, v10, 7, s4
    s_mov_b32 s6, 0
    s_add_u32 m0, s16, 16384
    s_nop 0
    buffer_load_dwordx4 v11, s[36:39], s6 offen offset:0  lds
    s_add_u32 m0, s58, 28672
    s_lshl1_add_u32 s4, s17, 28672
    buffer_load_dwordx4 v21, s[44:47], s4 offen sc1 lds
    s_add_u32 m0, s58, 32768
    s_lshl1_add_u32 s4, s18, 28672
    buffer_load_dwordx4 v21, s[44:47], s4 offen sc1 lds
    s_add_u32 m0, s58, 36864
    s_lshl1_add_u32 s4, s19, 28672
    buffer_load_dwordx4 v21, s[44:47], s4 offen sc1 lds
    s_add_u32 m0, s58, 40960
    s_lshl1_add_u32 s4, s8, 28672
    buffer_load_dwordx4 v21, s[44:47], s4 offen sc1 lds
    s_add_u32 m0, s58, 45056
    s_lshl1_add_u32 s4, s3, 28672
    buffer_load_dwordx4 v21, s[44:47], s4 offen sc1 lds
    s_add_u32 m0, s58, 49152
    s_lshl1_add_u32 s4, s57, 28672
    buffer_load_dwordx4 v21, s[44:47], s4 offen sc1 lds
    s_add_u32 m0, s58, 53248
    s_lshl1_add_u32 s4, s9, 28672
    buffer_load_dwordx4 v21, s[44:47], s4 offen sc1 lds
    s_add_u32 m0, s51, 163248
    s_mov_b64 exec, 1
    buffer_load_dword v2, s[44:47], s15 offen offset:128 sc1 lds
    s_mov_b64 exec, -1
    s_add_u32 m0, s16, 16384
    s_nop 0
    buffer_load_dwordx4 v12, s[36:39], s6 offen offset:1024  lds
    s_mov_b32 s6, 114688
    s_add_u32 m0, s16, 24576
    s_nop 0
    buffer_load_dwordx4 v11, s[36:39], s6 offen offset:0  lds
    s_add_u32 m0, s16, 24576
    s_nop 0
    buffer_load_dwordx4 v12, s[36:39], s6 offen offset:1024  lds
    s_mov_b32 s6, 229376
    s_add_u32 m0, s16, 32768
    s_nop 0
    buffer_load_dwordx4 v11, s[36:39], s6 offen offset:0  lds
    s_add_u32 m0, s16, 32768
    s_nop 0
    buffer_load_dwordx4 v12, s[36:39], s6 offen offset:1024  lds
    s_mov_b32 s6, 344064
    s_add_u32 m0, s16, 0
    s_nop 0
    buffer_load_dwordx4 v11, s[36:39], s6 offen offset:0  lds
    buffer_load_dword v88, v10, s[44:47], s54 offen offset:512 sc1
    s_waitcnt vmcnt(15)
    ds_read_b64_tr_b16 v[144:145], v13 offset:16384
    ds_read_b64_tr_b16 v[148:149], v14 offset:16384
    s_add_u32 m0, s16, 0
    s_nop 0
    buffer_load_dwordx4 v12, s[36:39], s6 offen offset:1024  lds
    s_waitcnt vmcnt(7)
    ds_read_b64_tr_b16 v[146:147], v13 offset:17408
    ds_read_b64_tr_b16 v[150:151], v14 offset:17408
    s_mov_b32 s6, 458752
    s_add_u32 m0, s16, 8192
    s_nop 0
    buffer_load_dwordx4 v11, s[36:39], s6 offen offset:0  lds
    s_waitcnt vmcnt(7)
    ds_read_b64_tr_b16 v[152:153], v13 offset:24576
    ds_read_b64_tr_b16 v[156:157], v14 offset:24576
    s_add_u32 m0, s16, 8192
    s_nop 0
    buffer_load_dwordx4 v12, s[36:39], s6 offen offset:1024  lds
    s_waitcnt vmcnt(7)
    ds_read_b64_tr_b16 v[154:155], v13 offset:25600
    ds_read_b64_tr_b16 v[158:159], v14 offset:25600
    s_waitcnt lgkmcnt(6)
    s_mov_b32 s6, 573440
    s_add_u32 m0, s16, 16384
    s_nop 0
    buffer_load_dwordx4 v11, s[36:39], s6 offen offset:0  lds
    s_waitcnt vmcnt(7)
    ds_read_b64_tr_b16 v[160:161], v13 offset:32768
    ds_read_b64_tr_b16 v[164:165], v14 offset:32768
    s_waitcnt lgkmcnt(6)
    s_add_u32 m0, s16, 16384
    s_nop 0
    buffer_load_dwordx4 v12, s[36:39], s6 offen offset:1024  lds
    s_waitcnt vmcnt(7)
    ds_read_b64_tr_b16 v[162:163], v13 offset:33792
    ds_read_b64_tr_b16 v[166:167], v14 offset:33792
    s_waitcnt lgkmcnt(6)
    s_mov_b32 s6, 688128
    s_add_u32 m0, s16, 24576
    s_nop 0
    buffer_load_dwordx4 v11, s[36:39], s6 offen offset:0  lds
    s_waitcnt vmcnt(7)
    ds_read_b64_tr_b16 v[168:169], v13 offset:0
    ds_read_b64_tr_b16 v[172:173], v14 offset:0
    s_waitcnt lgkmcnt(6)
    s_add_u32 m0, s16, 24576
    s_nop 0
    buffer_load_dwordx4 v12, s[36:39], s6 offen offset:1024  lds
    s_waitcnt vmcnt(6)
    ds_read_b64_tr_b16 v[170:171], v13 offset:1024
    ds_read_b64_tr_b16 v[174:175], v14 offset:1024
    s_waitcnt lgkmcnt(6)
    s_mov_b32 s6, 14336
    s_add_u32 m0, s16, 32768
    s_nop 0
    buffer_load_dwordx4 v11, s[36:39], s6 offen offset:0  lds
    s_waitcnt vmcnt(6)
    ds_read_b64_tr_b16 v[176:177], v13 offset:8192
    ds_read_b64_tr_b16 v[180:181], v14 offset:8192
    s_waitcnt lgkmcnt(6)
    s_add_u32 m0, s16, 32768
    s_nop 0
    buffer_load_dwordx4 v12, s[36:39], s6 offen offset:1024  lds
    s_waitcnt vmcnt(6)
    ds_read_b64_tr_b16 v[178:179], v13 offset:9216
    ds_read_b64_tr_b16 v[182:183], v14 offset:9216
    s_waitcnt lgkmcnt(6)
    s_mov_b32 s6, 129024
    s_add_u32 m0, s16, 0
    s_nop 0
    buffer_load_dwordx4 v11, s[36:39], s6 offen offset:0  lds
    s_waitcnt vmcnt(6)
    ds_read_b64_tr_b16 v[184:185], v13 offset:16384
    ds_read_b64_tr_b16 v[188:189], v14 offset:16384
    s_waitcnt lgkmcnt(6)
    s_add_u32 m0, s16, 0
    s_nop 0
    buffer_load_dwordx4 v12, s[36:39], s6 offen offset:1024  lds
    s_waitcnt vmcnt(6)
    ds_read_b64_tr_b16 v[186:187], v13 offset:17408
    ds_read_b64_tr_b16 v[190:191], v14 offset:17408
    s_waitcnt lgkmcnt(6)
    s_mov_b32 s6, 243712
    s_add_u32 m0, s16, 8192
    s_nop 0
    buffer_load_dwordx4 v11, s[36:39], s6 offen offset:0  lds
    s_waitcnt vmcnt(6)
    ds_read_b64_tr_b16 v[192:193], v13 offset:24576
    ds_read_b64_tr_b16 v[196:197], v14 offset:24576
    s_waitcnt lgkmcnt(6)
    s_add_u32 m0, s16, 8192
    s_nop 0
    buffer_load_dwordx4 v12, s[36:39], s6 offen offset:1024  lds
    s_waitcnt vmcnt(6)
    ds_read_b64_tr_b16 v[194:195], v13 offset:25600
    ds_read_b64_tr_b16 v[198:199], v14 offset:25600
    s_waitcnt lgkmcnt(6)
    s_mov_b32 s6, 358400
    s_add_u32 m0, s16, 16384
    s_nop 0
    buffer_load_dwordx4 v11, s[36:39], s6 offen offset:0  lds
    s_waitcnt vmcnt(6)
    ds_read_b64_tr_b16 v[200:201], v13 offset:32768
    ds_read_b64_tr_b16 v[204:205], v14 offset:32768
    s_waitcnt lgkmcnt(6)
    s_add_u32 m0, s16, 16384
    s_nop 0
    buffer_load_dwordx4 v12, s[36:39], s6 offen offset:1024  lds
    s_waitcnt vmcnt(6)
    ds_read_b64_tr_b16 v[202:203], v13 offset:33792
    ds_read_b64_tr_b16 v[206:207], v14 offset:33792
    s_waitcnt lgkmcnt(6)
    s_mov_b32 s6, 473088
    s_add_u32 m0, s16, 24576
    s_nop 0
    buffer_load_dwordx4 v11, s[36:39], s6 offen offset:0  lds
    s_waitcnt vmcnt(6)
    ds_read_b64_tr_b16 v[208:209], v13 offset:0
    ds_read_b64_tr_b16 v[212:213], v14 offset:0
    s_waitcnt lgkmcnt(6)
    s_add_u32 m0, s16, 24576
    s_nop 0
    buffer_load_dwordx4 v12, s[36:39], s6 offen offset:1024  lds
    s_waitcnt vmcnt(6)
    ds_read_b64_tr_b16 v[210:211], v13 offset:1024
    ds_read_b64_tr_b16 v[214:215], v14 offset:1024
    s_waitcnt lgkmcnt(6)
    s_mov_b32 s6, 587776
    s_add_u32 m0, s16, 32768
    s_nop 0
    buffer_load_dwordx4 v11, s[36:39], s6 offen offset:0  lds
    buffer_load_dword v15, v9, s[44:47], s10 offen offset:512 sc1
    s_waitcnt vmcnt(7)
    ds_read_b64_tr_b16 v[216:217], v13 offset:8192
    ds_read_b64_tr_b16 v[220:221], v14 offset:8192
    s_waitcnt lgkmcnt(6)
    s_add_u32 m0, s16, 32768
    s_nop 0
    buffer_load_dwordx4 v12, s[36:39], s6 offen offset:1024  lds
    s_waitcnt vmcnt(7)
    ds_read_b64_tr_b16 v[218:219], v13 offset:9216
    ds_read_b64_tr_b16 v[222:223], v14 offset:9216
    s_waitcnt lgkmcnt(6)
    s_mov_b32 s6, 702464
    s_add_u32 m0, s16, 0
    s_nop 0
    buffer_load_dwordx4 v11, s[36:39], s6 offen offset:0  lds
    s_waitcnt vmcnt(7)
    ds_read_b64_tr_b16 v[224:225], v13 offset:16384
    ds_read_b64_tr_b16 v[228:229], v14 offset:16384
    s_waitcnt lgkmcnt(6)
    s_add_u32 m0, s16, 0
    s_nop 0
    buffer_load_dwordx4 v12, s[36:39], s6 offen offset:1024  lds
    s_waitcnt vmcnt(7)
    ds_read_b64_tr_b16 v[226:227], v13 offset:17408
    ds_read_b64_tr_b16 v[230:231], v14 offset:17408
    s_add_u32 s11, s53, 1
    s_waitcnt vmcnt(3)
    v_subrev_u32 v20, s11, v15
    v_cmp_le_u32 vcc, 15, v20
    s_cbranch_vccnz Lslowcnt_39
Lback_40:
    s_setprio 1
    buffer_load_dwordx4 v[88:91], v22, s[40:43], s60 offen sc1
    ds_read_b64_tr_b16 v[232:233], v13 offset:24576
    ds_read_b64_tr_b16 v[236:237], v14 offset:24576
    buffer_load_dwordx4 v[92:95], v22, s[40:43], s61 offen sc1
    ds_read_b64_tr_b16 v[234:235], v13 offset:25600
    ds_read_b64_tr_b16 v[238:239], v14 offset:25600
    buffer_load_dwordx4 v[96:99], v22, s[40:43], s62 offen sc1
    ds_read_b64_tr_b16 v[240:241], v13 offset:32768
    ds_read_b64_tr_b16 v[244:245], v14 offset:32768
    buffer_load_dwordx4 v[100:103], v22, s[40:43], s63 offen sc1
    s_waitcnt vmcnt(6)
    ds_read_b64_tr_b16 v[242:243], v13 offset:33792
    ds_read_b64_tr_b16 v[246:247], v14 offset:33792
    buffer_load_dwordx4 v[104:107], v22, s[40:43], s64 offen sc1
    s_waitcnt vmcnt(6)
    ds_read_b64_tr_b16 v[248:249], v13 offset:0
    ds_read_b64_tr_b16 v[252:253], v14 offset:0
    buffer_load_dwordx4 v[108:111], v22, s[40:43], s65 offen sc1
    s_waitcnt vmcnt(6)
    ds_read_b64_tr_b16 v[250:251], v13 offset:1024
    ds_read_b64_tr_b16 v[254:255], v14 offset:1024
    buffer_load_dwordx4 v[112:115], v22, s[40:43], s66 offen sc1
    v_add_u32 v22, 7168, v22
    buffer_load_dwordx4 v[116:119], v22, s[40:43], s60 offen sc1
    s_waitcnt lgkmcnt(0)
    v_subrev_u32 v11, 57344, v16
    v_subrev_u32 v12, 57344, v17
    v_subrev_u32 v13, 57344, v18
    v_subrev_u32 v14, 57344, v23
    s_waitcnt vmcnt(7)
    v_mfma_f32_32x32x16_bf16 v[24:39], v[144:147], v[88:91], 0
    buffer_load_dwordx4 v[120:123], v22, s[40:43], s61 offen sc1
    buffer_load_dword v10, v9, s[44:47], s10 offen offset:512 sc1
    s_waitcnt vmcnt(8)
    v_mfma_f32_32x32x16_bf16 v[24:39], v[152:155], v[92:95], v[24:39]
    buffer_load_dwordx4 v[124:127], v22, s[40:43], s62 offen sc1
    s_waitcnt vmcnt(8)
    v_mfma_f32_32x32x16_bf16 v[24:39], v[160:163], v[96:99], v[24:39]
    buffer_load_dwordx4 v[128:131], v22, s[40:43], s63 offen sc1
    s_waitcnt vmcnt(8)
    v_mfma_f32_32x32x16_bf16 v[24:39], v[168:171], v[100:103], v[24:39]
    buffer_load_dwordx4 v[132:135], v22, s[40:43], s64 offen sc1
    s_waitcnt vmcnt(8)
    v_mfma_f32_32x32x16_bf16 v[24:39], v[176:179], v[104:107], v[24:39]
    buffer_load_dwordx4 v[136:139], v22, s[40:43], s65 offen sc1
    s_waitcnt vmcnt(8)
    v_mfma_f32_32x32x16_bf16 v[24:39], v[184:187], v[108:111], v[24:39]
    buffer_load_dwordx4 v[140:143], v22, s[40:43], s66 offen sc1
    v_mfma_f32_32x32x16_bf16 v[40:55], v[148:151], v[88:91], 0
    s_waitcnt vmcnt(8)
    v_mfma_f32_32x32x16_bf16 v[24:39], v[192:195], v[112:115], v[24:39]
    s_add_u32 s11, s53, 3
    s_waitcnt vmcnt(5)
    v_subrev_u32 v20, s11, v10
    v_cmp_le_u32 vcc, 13, v20
    s_cbranch_vccnz Lslowcnt_41
Lback_42:
    buffer_load_dwordx4 v[88:91], v4, s[44:47], s60 offen sc1
    v_mfma_f32_32x32x16_bf16 v[40:55], v[156:159], v[92:95], v[40:55]
    v_mfma_f32_32x32x16_bf16 v[24:39], v[200:203], v[116:119], v[24:39]
    buffer_load_dwordx4 v[92:95], v4, s[44:47], s61 offen sc1
    v_mfma_f32_32x32x16_bf16 v[40:55], v[164:167], v[96:99], v[40:55]
    v_mfma_f32_32x32x16_bf16 v[24:39], v[208:211], v[120:123], v[24:39]
    buffer_load_dwordx4 v[96:99], v4, s[44:47], s62 offen sc1
    v_mfma_f32_32x32x16_bf16 v[40:55], v[172:175], v[100:103], v[40:55]
    s_waitcnt vmcnt(7)
    v_mfma_f32_32x32x16_bf16 v[24:39], v[216:219], v[124:127], v[24:39]
    buffer_load_dwordx4 v[100:103], v4, s[44:47], s63 offen sc1
    v_mfma_f32_32x32x16_bf16 v[40:55], v[180:183], v[104:107], v[40:55]
    s_waitcnt vmcnt(7)
    v_mfma_f32_32x32x16_bf16 v[24:39], v[224:227], v[128:131], v[24:39]
    buffer_load_dwordx4 v[104:107], v4, s[44:47], s64 offen sc1
    v_mfma_f32_32x32x16_bf16 v[40:55], v[188:191], v[108:111], v[40:55]
    s_waitcnt vmcnt(7)
    v_mfma_f32_32x32x16_bf16 v[24:39], v[232:235], v[132:135], v[24:39]
    buffer_load_dwordx4 v[108:111], v4, s[44:47], s65 offen sc1
    buffer_load_dword v10, v9, s[44:47], s10 offen offset:512 sc1
    v_mfma_f32_32x32x16_bf16 v[40:55], v[196:199], v[112:115], v[40:55]
    s_waitcnt vmcnt(8)
    v_mfma_f32_32x32x16_bf16 v[24:39], v[240:243], v[136:139], v[24:39]
    buffer_load_dwordx4 v[112:115], v4, s[44:47], s66 offen sc1
    v_mfma_f32_32x32x16_bf16 v[40:55], v[204:207], v[116:119], v[40:55]
    s_waitcnt vmcnt(8)
    v_mfma_f32_32x32x16_bf16 v[24:39], v[248:251], v[140:143], v[24:39]
    buffer_store_dword v3, v8, s[44:47], s15 offen offset:1920 sc1
    v_add_u32 v4, 7168, v4
    buffer_load_dwordx4 v[116:119], v4, s[44:47], s60 offen sc1
    v_mfma_f32_32x32x16_bf16 v[40:55], v[212:215], v[120:123], v[40:55]
    s_waitcnt vmcnt(9)
    v_mfma_f32_32x32x16_bf16 v[56:71], v[144:147], v[88:91], 0
    buffer_load_dwordx4 v[120:123], v4, s[44:47], s61 offen sc1
    v_mfma_f32_32x32x16_bf16 v[40:55], v[220:223], v[124:127], v[40:55]
    s_waitcnt vmcnt(9)
    v_mfma_f32_32x32x16_bf16 v[56:71], v[152:155], v[92:95], v[56:71]
    buffer_load_dwordx4 v[124:127], v4, s[44:47], s62 offen sc1
    v_mfma_f32_32x32x16_bf16 v[40:55], v[228:231], v[128:131], v[40:55]
    ds_write_b128 v16, v[24:27] offset:0
    s_waitcnt vmcnt(9)
    v_mfma_f32_32x32x16_bf16 v[56:71], v[160:163], v[96:99], v[56:71]
    buffer_load_dwordx4 v[128:131], v4, s[44:47], s63 offen sc1
    v_mfma_f32_32x32x16_bf16 v[40:55], v[236:239], v[132:135], v[40:55]
    ds_write_b128 v17, v[28:31] offset:0
    s_waitcnt vmcnt(9)
    v_mfma_f32_32x32x16_bf16 v[56:71], v[168:171], v[100:103], v[56:71]
    buffer_load_dwordx4 v[132:135], v4, s[44:47], s64 offen sc1
    v_mfma_f32_32x32x16_bf16 v[40:55], v[244:247], v[136:139], v[40:55]
    ds_write_b128 v18, v[32:35] offset:0
    s_waitcnt vmcnt(9)
    v_mfma_f32_32x32x16_bf16 v[56:71], v[176:179], v[104:107], v[56:71]
    buffer_load_dwordx4 v[136:139], v4, s[44:47], s65 offen sc1
    v_mfma_f32_32x32x16_bf16 v[40:55], v[252:255], v[140:143], v[40:55]
    ds_write_b128 v23, v[36:39] offset:0
    s_waitcnt vmcnt(9)
    v_mfma_f32_32x32x16_bf16 v[56:71], v[184:187], v[108:111], v[56:71]
    buffer_load_dwordx4 v[140:143], v4, s[44:47], s66 offen sc1
    v_mfma_f32_32x32x16_bf16 v[72:87], v[148:151], v[88:91], 0
    s_waitcnt vmcnt(8)
    v_mfma_f32_32x32x16_bf16 v[56:71], v[192:195], v[112:115], v[56:71]
    s_add_u32 s11, s53, 5
    v_subrev_u32 v20, s11, v10
    v_cmp_le_u32 vcc, 11, v20
    s_cbranch_vccnz Lslowcnt_43
Lback_44:
    buffer_load_dwordx4 v[88:91], v5, s[44:47], s60 offen sc1
    v_mfma_f32_32x32x16_bf16 v[72:87], v[156:159], v[92:95], v[72:87]
    ds_write_b128 v16, v[40:43] offset:128
    s_waitcnt vmcnt(7)
    v_mfma_f32_32x32x16_bf16 v[56:71], v[200:203], v[116:119], v[56:71]
    buffer_load_dwordx4 v[92:95], v5, s[44:47], s61 offen sc1
    v_mfma_f32_32x32x16_bf16 v[72:87], v[164:167], v[96:99], v[72:87]
    ds_write_b128 v17, v[44:47] offset:128
    s_waitcnt vmcnt(7)
    v_mfma_f32_32x32x16_bf16 v[56:71], v[208:211], v[120:123], v[56:71]
    buffer_load_dwordx4 v[96:99], v5, s[44:47], s62 offen sc1
    v_mfma_f32_32x32x16_bf16 v[72:87], v[172:175], v[100:103], v[72:87]
    ds_write_b128 v18, v[48:51] offset:128
    s_waitcnt vmcnt(7)
    v_mfma_f32_32x32x16_bf16 v[56:71], v[216:219], v[124:127], v[56:71]
    buffer_load_dwordx4 v[100:103], v5, s[44:47], s63 offen sc1
    v_mfma_f32_32x32x16_bf16 v[72:87], v[180:183], v[104:107], v[72:87]
    ds_write_b128 v23, v[52:55] offset:128
    s_waitcnt vmcnt(7)
    v_mfma_f32_32x32x16_bf16 v[56:71], v[224:227], v[128:131], v[56:71]
    buffer_load_dwordx4 v[104:107], v5, s[44:47], s64 offen sc1
    v_mfma_f32_32x32x16_bf16 v[72:87], v[188:191], v[108:111], v[72:87]
    s_waitcnt vmcnt(7)
    v_mfma_f32_32x32x16_bf16 v[56:71], v[232:235], v[132:135], v[56:71]
    buffer_load_dwordx4 v[108:111], v5, s[44:47], s65 offen sc1
    buffer_load_dword v10, v9, s[44:47], s10 offen offset:512 sc1
    v_mfma_f32_32x32x16_bf16 v[72:87], v[196:199], v[112:115], v[72:87]
    s_waitcnt lgkmcnt(0)
    s_barrier
    s_waitcnt vmcnt(8)
    v_mfma_f32_32x32x16_bf16 v[56:71], v[240:243], v[136:139], v[56:71]
    buffer_load_dwordx4 v[112:115], v5, s[44:47], s66 offen sc1
    v_mfma_f32_32x32x16_bf16 v[72:87], v[204:207], v[116:119], v[72:87]
    s_waitcnt vmcnt(8)
    v_mfma_f32_32x32x16_bf16 v[56:71], v[248:251], v[140:143], v[56:71]
    v_add_u32 v5, 7168, v5
    buffer_load_dwordx4 v[116:119], v5, s[44:47], s60 offen sc1
    v_mfma_f32_32x32x16_bf16 v[72:87], v[212:215], v[120:123], v[72:87]
    s_waitcnt vmcnt(8)
    v_mfma_f32_32x32x16_bf16 v[24:39], v[144:147], v[88:91], 0
    buffer_load_dwordx4 v[120:123], v5, s[44:47], s61 offen sc1
    v_mfma_f32_32x32x16_bf16 v[72:87], v[220:223], v[124:127], v[72:87]
    s_waitcnt vmcnt(8)
    v_mfma_f32_32x32x16_bf16 v[24:39], v[152:155], v[92:95], v[24:39]
    buffer_load_dwordx4 v[124:127], v5, s[44:47], s62 offen sc1
    v_mfma_f32_32x32x16_bf16 v[72:87], v[228:231], v[128:131], v[72:87]
    s_nop 0
    ds_write_b128 v11, v[56:59] offset:0
    s_waitcnt vmcnt(8)
    v_mfma_f32_32x32x16_bf16 v[24:39], v[160:163], v[96:99], v[24:39]
    buffer_load_dwordx4 v[128:131], v5, s[44:47], s63 offen sc1
    v_mfma_f32_32x32x16_bf16 v[72:87], v[236:239], v[132:135], v[72:87]
    ds_write_b128 v12, v[60:63] offset:0
    s_waitcnt vmcnt(8)
    v_mfma_f32_32x32x16_bf16 v[24:39], v[168:171], v[100:103], v[24:39]
    buffer_load_dwordx4 v[132:135], v5, s[44:47], s64 offen sc1
    v_mfma_f32_32x32x16_bf16 v[72:87], v[244:247], v[136:139], v[72:87]
    ds_write_b128 v13, v[64:67] offset:0
    s_waitcnt vmcnt(8)
    v_mfma_f32_32x32x16_bf16 v[24:39], v[176:179], v[104:107], v[24:39]
    buffer_load_dwordx4 v[136:139], v5, s[44:47], s65 offen sc1
    v_mfma_f32_32x32x16_bf16 v[72:87], v[252:255], v[140:143], v[72:87]
    ds_write_b128 v14, v[68:71] offset:0
    s_waitcnt vmcnt(8)
    v_mfma_f32_32x32x16_bf16 v[24:39], v[184:187], v[108:111], v[24:39]
    buffer_load_dwordx4 v[140:143], v5, s[44:47], s66 offen sc1
    v_mfma_f32_32x32x16_bf16 v[40:55], v[148:151], v[88:91], 0
    s_waitcnt vmcnt(7)
    v_mfma_f32_32x32x16_bf16 v[24:39], v[192:195], v[112:115], v[24:39]
    s_add_u32 s11, s53, 7
    v_subrev_u32 v20, s11, v10
    v_cmp_le_u32 vcc, 9, v20
    s_cbranch_vccnz Lslowcnt_45
Lback_46:
    buffer_load_dwordx4 v[88:91], v6, s[44:47], s60 offen sc1
    v_mfma_f32_32x32x16_bf16 v[40:55], v[156:159], v[92:95], v[40:55]
    ds_write_b128 v11, v[72:75] offset:128
    s_waitcnt vmcnt(7)
    v_mfma_f32_32x32x16_bf16 v[24:39], v[200:203], v[116:119], v[24:39]
    buffer_load_dwordx4 v[92:95], v6, s[44:47], s61 offen sc1
    v_mfma_f32_32x32x16_bf16 v[40:55], v[164:167], v[96:99], v[40:55]
    ds_write_b128 v12, v[76:79] offset:128
    s_waitcnt vmcnt(7)
    v_mfma_f32_32x32x16_bf16 v[24:39], v[208:211], v[120:123], v[24:39]
    buffer_load_dwordx4 v[96:99], v6, s[44:47], s62 offen sc1
    v_mfma_f32_32x32x16_bf16 v[40:55], v[172:175], v[100:103], v[40:55]
    ds_write_b128 v13, v[80:83] offset:128
    s_waitcnt vmcnt(7)
    v_mfma_f32_32x32x16_bf16 v[24:39], v[216:219], v[124:127], v[24:39]
    buffer_load_dwordx4 v[100:103], v6, s[44:47], s63 offen sc1
    v_mfma_f32_32x32x16_bf16 v[40:55], v[180:183], v[104:107], v[40:55]
    ds_write_b128 v14, v[84:87] offset:128
    s_waitcnt vmcnt(7)
    v_mfma_f32_32x32x16_bf16 v[24:39], v[224:227], v[128:131], v[24:39]
    buffer_load_dwordx4 v[104:107], v6, s[44:47], s64 offen sc1
    v_mfma_f32_32x32x16_bf16 v[40:55], v[188:191], v[108:111], v[40:55]
    s_waitcnt vmcnt(7)
    v_mfma_f32_32x32x16_bf16 v[24:39], v[232:235], v[132:135], v[24:39]
    buffer_load_dwordx4 v[108:111], v6, s[44:47], s65 offen sc1
    v_mfma_f32_32x32x16_bf16 v[40:55], v[196:199], v[112:115], v[40:55]
    s_waitcnt lgkmcnt(0)
    s_barrier
    s_waitcnt vmcnt(7)
    v_mfma_f32_32x32x16_bf16 v[24:39], v[240:243], v[136:139], v[24:39]
    buffer_load_dwordx4 v[112:115], v6, s[44:47], s66 offen sc1
    v_mfma_f32_32x32x16_bf16 v[40:55], v[204:207], v[116:119], v[40:55]
    s_waitcnt vmcnt(7)
    v_mfma_f32_32x32x16_bf16 v[24:39], v[248:251], v[140:143], v[24:39]
    v_add_u32 v6, 7168, v6
    buffer_load_dwordx4 v[116:119], v6, s[44:47], s60 offen sc1
    v_mfma_f32_32x32x16_bf16 v[40:55], v[212:215], v[120:123], v[40:55]
    s_waitcnt vmcnt(7)
    v_mfma_f32_32x32x16_bf16 v[56:71], v[144:147], v[88:91], 0
    buffer_load_dwordx4 v[120:123], v6, s[44:47], s61 offen sc1
    v_mfma_f32_32x32x16_bf16 v[40:55], v[220:223], v[124:127], v[40:55]
    s_waitcnt vmcnt(7)
    v_mfma_f32_32x32x16_bf16 v[56:71], v[152:155], v[92:95], v[56:71]
    buffer_load_dwordx4 v[124:127], v6, s[44:47], s62 offen sc1
    v_mfma_f32_32x32x16_bf16 v[40:55], v[228:231], v[128:131], v[40:55]
    s_nop 0
    ds_write_b128 v16, v[24:27] offset:0
    s_waitcnt vmcnt(7)
    v_mfma_f32_32x32x16_bf16 v[56:71], v[160:163], v[96:99], v[56:71]
    buffer_load_dwordx4 v[128:131], v6, s[44:47], s63 offen sc1
    v_mfma_f32_32x32x16_bf16 v[40:55], v[236:239], v[132:135], v[40:55]
    ds_write_b128 v17, v[28:31] offset:0
    s_waitcnt vmcnt(7)
    v_mfma_f32_32x32x16_bf16 v[56:71], v[168:171], v[100:103], v[56:71]
    buffer_load_dwordx4 v[132:135], v6, s[44:47], s64 offen sc1
    v_mfma_f32_32x32x16_bf16 v[40:55], v[244:247], v[136:139], v[40:55]
    ds_write_b128 v18, v[32:35] offset:0
    s_waitcnt vmcnt(7)
    v_mfma_f32_32x32x16_bf16 v[56:71], v[176:179], v[104:107], v[56:71]
    buffer_load_dwordx4 v[136:139], v6, s[44:47], s65 offen sc1
    v_mfma_f32_32x32x16_bf16 v[40:55], v[252:255], v[140:143], v[40:55]
    ds_write_b128 v23, v[36:39] offset:0
    s_waitcnt vmcnt(7)
    v_mfma_f32_32x32x16_bf16 v[56:71], v[184:187], v[108:111], v[56:71]
    buffer_load_dwordx4 v[140:143], v6, s[44:47], s66 offen sc1
    v_mfma_f32_32x32x16_bf16 v[72:87], v[148:151], v[88:91], 0
    s_waitcnt vmcnt(7)
    v_mfma_f32_32x32x16_bf16 v[56:71], v[192:195], v[112:115], v[56:71]
    v_mfma_f32_32x32x16_bf16 v[72:87], v[156:159], v[92:95], v[72:87]
    s_nop 3
    ds_write_b128 v16, v[40:43] offset:128
    s_waitcnt vmcnt(6)
    v_mfma_f32_32x32x16_bf16 v[56:71], v[200:203], v[116:119], v[56:71]
    v_mfma_f32_32x32x16_bf16 v[72:87], v[164:167], v[96:99], v[72:87]
    ds_write_b128 v17, v[44:47] offset:128
    s_waitcnt vmcnt(5)
    v_mfma_f32_32x32x16_bf16 v[56:71], v[208:211], v[120:123], v[56:71]
    v_mfma_f32_32x32x16_bf16 v[72:87], v[172:175], v[100:103], v[72:87]
    ds_write_b128 v18, v[48:51] offset:128
    s_waitcnt vmcnt(4)
    v_mfma_f32_32x32x16_bf16 v[56:71], v[216:219], v[124:127], v[56:71]
    v_mfma_f32_32x32x16_bf16 v[72:87], v[180:183], v[104:107], v[72:87]
    ds_write_b128 v23, v[52:55] offset:128
    s_waitcnt vmcnt(3)
    v_mfma_f32_32x32x16_bf16 v[56:71], v[224:227], v[128:131], v[56:71]
    v_mfma_f32_32x32x16_bf16 v[72:87], v[188:191], v[108:111], v[72:87]
    s_waitcnt vmcnt(2)
    v_mfma_f32_32x32x16_bf16 v[56:71], v[232:235], v[132:135], v[56:71]
    v_mfma_f32_32x32x16_bf16 v[72:87], v[196:199], v[112:115], v[72:87]
    s_waitcnt lgkmcnt(0)
    s_barrier
    s_waitcnt vmcnt(1)
    v_mfma_f32_32x32x16_bf16 v[56:71], v[240:243], v[136:139], v[56:71]
    v_mfma_f32_32x32x16_bf16 v[72:87], v[204:207], v[116:119], v[72:87]
    s_waitcnt vmcnt(0)
    v_mfma_f32_32x32x16_bf16 v[56:71], v[248:251], v[140:143], v[56:71]
    v_mfma_f32_32x32x16_bf16 v[72:87], v[212:215], v[120:123], v[72:87]
    v_mfma_f32_32x32x16_bf16 v[72:87], v[220:223], v[124:127], v[72:87]
    v_mfma_f32_32x32x16_bf16 v[72:87], v[228:231], v[128:131], v[72:87]
    s_nop 8
    ds_write_b128 v11, v[56:59] offset:0
    v_mfma_f32_32x32x16_bf16 v[72:87], v[236:239], v[132:135], v[72:87]
    ds_write_b128 v12, v[60:63] offset:0
    v_mfma_f32_32x32x16_bf16 v[72:87], v[244:247], v[136:139], v[72:87]
    ds_write_b128 v13, v[64:67] offset:0
    v_mfma_f32_32x32x16_bf16 v[72:87], v[252:255], v[140:143], v[72:87]
    ds_write_b128 v14, v[68:71] offset:0
    s_or_b32 s4, s52, s49
    s_or_b32 s4, s4, s48
    s_min_u32 s4, s4, 1
    s_lshl_b32 s4, s4, 31
    v_or_b32 v20, s4, v8
    buffer_store_dword v3, v20, s[44:47], s54 offen offset:384
    s_nop 4
    ds_write_b128 v11, v[72:75] offset:128
    ds_write_b128 v12, v[76:79] offset:128
    ds_write_b128 v13, v[80:83] offset:128
    ds_write_b128 v14, v[84:87] offset:128
    s_waitcnt lgkmcnt(0)
    s_barrier
    s_endpgm
Lslow4_25:
    ds_read_b128 v[20:23], v9 offset:0
    s_add_u32 s59, s59, 1
    s_cmp_gt_u32 s59, 0x100000
    s_cbranch_scc1 Lend
    s_waitcnt lgkmcnt(0)
    v_min3_u32 v20, v20, v21, v22
    v_min_u32 v20, v20, v23
    v_cmp_ne_u32 vcc, s53, v20
    s_cbranch_vccnz Lslow4_25
    s_branch Lback_26
Lslow4_27:
    ds_read_b128 v[20:23], v9 offset:16
    s_add_u32 s59, s59, 1
    s_cmp_gt_u32 s59, 0x100000
    s_cbranch_scc1 Lend
    s_waitcnt lgkmcnt(0)
    v_min3_u32 v20, v20, v21, v22
    v_min_u32 v20, v20, v23
    v_cmp_ne_u32 vcc, s53, v20
    s_cbranch_vccnz Lslow4_27
    s_branch Lback_28
Lslow4_29:
    ds_read_b128 v[20:23], v9 offset:32
    s_add_u32 s59, s59, 1
    s_cmp_gt_u32 s59, 0x100000
    s_cbranch_scc1 Lend
    s_waitcnt lgkmcnt(0)
    v_min3_u32 v20, v20, v21, v22
    v_min_u32 v20, v20, v23
    v_cmp_ne_u32 vcc, s53, v20
    s_cbranch_vccnz Lslow4_29
    s_branch Lback_30
Lslow4_31:
    ds_read_b128 v[20:23], v9 offset:48
    s_add_u32 s59, s59, 1
    s_cmp_gt_u32 s59, 0x100000
    s_cbranch_scc1 Lend
    s_waitcnt lgkmcnt(0)
    v_min3_u32 v20, v20, v21, v22
    v_min_u32 v20, v20, v23
    v_cmp_ne_u32 vcc, s53, v20
    s_cbranch_vccnz Lslow4_31
    s_branch Lback_32
Lslowpoll_33:
    s_sleep 8
    buffer_load_dword v22, v23, s[44:47], s54 offen offset:1920 sc1
    s_add_u32 s59, s59, 1
    s_cmp_gt_u32 s59, 0x100000
    s_cbranch_scc1 Lend
    s_waitcnt vmcnt(0)
    v_cmp_ne_u32 vcc, s53, v22
    s_cbranch_vccnz Lslowpoll_33
    s_branch Lback_34
Lslowpoll_35:
    s_sleep 8
    buffer_load_dword v22, v2, s[44:47], s13 offen offset:1024 sc1
    s_add_u32 s59, s59, 1
    s_cmp_gt_u32 s59, 0x100000
    s_cbranch_scc1 Lend
    s_waitcnt vmcnt(0)
    v_cmp_ne_u32 vcc, s53, v22
    s_cbranch_vccnz Lslowpoll_35
    s_branch Lback_36
Lslowcnt_39:
    s_sleep 8
    buffer_load_dword v15, v9, s[44:47], s10 offen offset:512 sc1
    s_add_u32 s59, s59, 1
    s_cmp_gt_u32 s59, 0x100000
    s_cbranch_scc1 Lend
    s_waitcnt vmcnt(0)
    s_add_u32 s11, s53, 1
    v_subrev_u32 v20, s11, v15
    v_cmp_le_u32 vcc, 15, v20
    s_cbranch_vccnz Lslowcnt_39
    s_branch Lback_40
Lslowcnt_41:
    s_sleep 8
    buffer_load_dword v10, v9, s[44:47], s10 offen offset:512 sc1
    s_add_u32 s59, s59, 1
    s_cmp_gt_u32 s59, 0x100000
    s_cbranch_scc1 Lend
    s_waitcnt vmcnt(0)
    s_add_u32 s11, s53, 3
    v_subrev_u32 v20, s11, v10
    v_cmp_le_u32 vcc, 13, v20
    s_cbranch_vccnz Lslowcnt_41
    s_branch Lback_42
Lslowcnt_43:
    s_sleep 8
    buffer_load_dword v10, v9, s[44:47], s10 offen offset:512 sc1
    s_add_u32 s59, s59, 1
    s_cmp_gt_u32 s59, 0x100000
    s_cbranch_scc1 Lend
    s_waitcnt vmcnt(0)
    s_add_u32 s11, s53, 5
    v_subrev_u32 v20, s11, v10
    v_cmp_le_u32 vcc, 11, v20
    s_cbranch_vccnz Lslowcnt_43
    s_branch Lback_44
Lslowcnt_45:
    s_sleep 8
    buffer_load_dword v10, v9, s[44:47], s10 offen offset:512 sc1
    s_add_u32 s59, s59, 1
    s_cmp_gt_u32 s59, 0x100000
    s_cbranch_scc1 Lend
    s_waitcnt vmcnt(0)
    s_add_u32 s11, s53, 7
    v_subrev_u32 v20, s11, v10
    v_cmp_le_u32 vcc, 9, v20
    s_cbranch_vccnz Lslowcnt_45
    s_branch Lback_46
    s_endpgm
.section .rodata,"a"
.p2align 6
.amdhsa_kernel standalone__mixer_s_mlp__prompt_kernel
  .amdhsa_next_free_vgpr 256
  .amdhsa_next_free_sgpr 102
  .amdhsa_accum_offset 256
  .amdhsa_group_segment_fixed_size 0
  .amdhsa_kernarg_size 64
  .amdhsa_user_sgpr_count 2
  .amdhsa_user_sgpr_kernarg_segment_ptr 1
  .amdhsa_system_sgpr_workgroup_id_x 1
.end_amdhsa_kernel
```
